```python
import torch

def _softmax(x, axis=-1):
    return torch.softmax(x, dim=axis)
def _gelu(x):
    return torch.nn.functional.gelu(x, approximate="tanh")
def _silu(x):
    return torch.nn.functional.silu(x)
def _sigmoid(x):
    return torch.sigmoid(x)
def _layernorm(x, axis=-1, eps=1e-5):
    m = x.mean(dim=axis, keepdim=True)
    v = x.var(dim=axis, keepdim=True, unbiased=False)
    return (x - m) / torch.sqrt(v + eps)
def _scatter_add(tgt, idx, src, axis=0):
    return tgt.clone().index_add_(axis, idx, src)
def _segment_sum(src, seg, n):
    out = torch.zeros((n,) + src.shape[1:], dtype=src.dtype)
    return out.index_add_(0, seg, src)
def _pad(x, pw):
    flat = tuple(v for pair in reversed(pw) for v in pair)
    return torch.nn.functional.pad(x, flat)

kernel_name = 'concat_heads__gqa_block_cached__sliding_block_cached__decode'

def setup_inputs():

    _w = (lambda a: (lambda t: t.to(torch.bfloat16) if t.is_floating_point() else t)(torch.as_tensor(a)))
    def _A_setup():
        B, Sq, D = 4, 1, 512
        Hq, Hkv, Sk, Dh = 32, 32, 8192, 128
        assert Hq % Hkv == 0, (Hq, Hkv)
        return {
            "x": _w((lambda *s: torch.randn(*s, dtype=torch.bfloat16) * 0.8)(B, Sq, D)),
            "k_cache": _w((lambda *s: torch.randn(*s, dtype=torch.bfloat16) * 1.6)(B, Hkv, Sk, Dh)),
            "v_cache": _w((lambda *s: torch.randn(*s, dtype=torch.bfloat16) * 0.2)(B, Hkv, Sk, Dh)),
            "wq": _w((lambda *s: torch.randn(*s, dtype=torch.bfloat16) * 1.6)(D, Hq * Dh) * (D ** -0.5)),
            "wo": _w((lambda *s: torch.randn(*s, dtype=torch.bfloat16) * 0.2)(Hq * Dh, D) * ((Hq * Dh) ** -0.5)),
        }
    _A_in = _A_setup()

    def _B_setup():
        B, Sq, D = 4, 1, 512
        Hq, Hkv, Sk, Dh = 32, 32, 8192, 128
        assert Hq % Hkv == 0, (Hq, Hkv)
        return {
            "x": _w((lambda *s: torch.randn(*s, dtype=torch.bfloat16) * 0.8)(B, Sq, D)),
            "k_cache": _w((lambda *s: torch.randn(*s, dtype=torch.bfloat16) * 1.6)(B, Hkv, Sk, Dh)),
            "v_cache": _w((lambda *s: torch.randn(*s, dtype=torch.bfloat16) * 0.2)(B, Hkv, Sk, Dh)),
            "wq": _w((lambda *s: torch.randn(*s, dtype=torch.bfloat16) * 1.6)(D, Hq * Dh) * (D ** -0.5)),
            "wo": _w((lambda *s: torch.randn(*s, dtype=torch.bfloat16) * 0.2)(Hq * Dh, D) * ((Hq * Dh) ** -0.5)),
        }
    _B_in = _B_setup()

    return {
        "A_x": _A_in["x"],
        "A_k_cache": _A_in["k_cache"],
        "A_v_cache": _A_in["v_cache"],
        "A_wq": _A_in["wq"],
        "A_wo": _A_in["wo"],
        "B_x": _B_in["x"],
        "B_k_cache": _B_in["k_cache"],
        "B_v_cache": _B_in["v_cache"],
        "B_wq": _B_in["wq"],
        "B_wo": _B_in["wo"],
    }

def reference(A_x, A_k_cache, A_v_cache, A_wq, A_wo, B_x, B_k_cache, B_v_cache, B_wq, B_wo):
    def _A_ref(x, k_cache, v_cache, wq, wo):
        B, Sq, D = x.shape
        Hq, Dh = 32, 128
        Hkv = k_cache.shape[1]
        rep = Hq // Hkv
        q = (lambda x, *d: x.permute(*d))((x @ wq).reshape(B, Sq, Hq, Dh), 0, 2, 1, 3)
        k = (lambda x, n, axis: torch.repeat_interleave(x, n, dim=axis))(k_cache, rep, axis=1)
        v = (lambda x, n, axis: torch.repeat_interleave(x, n, dim=axis))(v_cache, rep, axis=1)
        scores = torch.einsum("bhqd,bhkd->bhqk", q, k) * (Dh ** -0.5)
        p = _softmax(scores, axis=-1)
        o = torch.einsum("bhqk,bhkd->bhqd", p, v)
        return (lambda x, *d: x.permute(*d))(o, 0, 2, 1, 3).reshape(B, Sq, Hq * Dh) @ wo

    def _B_ref(x, k_cache, v_cache, wq, wo):
        B, Sq, D = x.shape
        Hq, Dh = 32, 128
        Hkv, Sk = k_cache.shape[1], k_cache.shape[2]
        W = min(4096, max(256, Sk // 4))
        rep = Hq // Hkv
        q = (lambda x, *d: x.permute(*d))((x @ wq).reshape(B, Sq, Hq, Dh), 0, 2, 1, 3)
        k = (lambda x, n, axis: torch.repeat_interleave(x, n, dim=axis))(k_cache[:, :, Sk - W:, :], rep, axis=1)
        v = (lambda x, n, axis: torch.repeat_interleave(x, n, dim=axis))(v_cache[:, :, Sk - W:, :], rep, axis=1)
        scores = torch.einsum("bhqd,bhkd->bhqk", q, k) * (Dh ** -0.5)
        p = _softmax(scores, axis=-1)
        o = torch.einsum("bhqk,bhkd->bhqd", p, v)
        return (lambda x, *d: x.permute(*d))(o, 0, 2, 1, 3).reshape(B, Sq, Hq * Dh) @ wo

    a = _A_ref(A_x, A_k_cache, A_v_cache, A_wq, A_wo)
    b = _B_ref(B_x, B_k_cache, B_v_cache, B_wq, B_wo)
    return torch.concatenate([a, b], axis=-1)
```

```asm
; @launch grid=(256,1,1) block=(320,1,1) lds=157696
.amdgcn_target "amdgcn-amd-amdhsa--gfx950"
.text
.globl concat_heads__gqa_block_cached__sliding_block_cached__decode_kernel
.p2align 8
.type concat_heads__gqa_block_cached__sliding_block_cached__decode_kernel,@function
concat_heads__gqa_block_cached__sliding_block_cached__decode_kernel:
    s_load_dwordx16 s[4:19], s[0:1], 0
    s_load_dwordx8 s[20:27], s[0:1], 64
    s_load_dwordx2 s[28:29], s[0:1], 96
    s_cmpk_ge_u32 s2, 256
    s_cbranch_scc1 L_end
    s_getpc_b64 s[30:31]
L_pc:
    v_lshlrev_b32 v247, 7, v0
    v_min_u32 v247, L_end-L_pc, v247
    global_load_dword v247, v247, s[30:31]
    v_lshrrev_b32 v19, 4, v0
    v_and_b32 v20, 15, v0
    v_cmp_le_u32 vcc, 16, v19
    v_lshlrev_b32 v20, 4, v20
    s_and_b32 s45, s2, 7
    s_lshr_b32 s56, s2, 6
    s_lshl3_add_u32 s45, s56, s45
    s_lshl_b32 s38, 1, 22
    s_mov_b32 s39, 0x20000
    s_cbranch_vccnz L_helper
    v_lshl_add_u32 v20, v19, 16, v20
    s_and_b32 s56, s2, 0x18
    s_lshl_b32 s57, s56, 9
    s_add_u32 s57, s57, s45
    s_lshl_b32 s57, s57, 8
    s_bitcmp0_b32 s2, 5
    s_waitcnt lgkmcnt(0)
    s_cselect_b32 s36, s10, s20
    s_cselect_b32 s37, s11, s21
    buffer_load_dwordx4 v[80:83], v20, s[36:39], s57 offen nt
    s_cselect_b32 s30, s4, s14
    s_cselect_b32 s31, s5, s15
    s_cselect_b32 s60, s12, s22
    s_cselect_b32 s61, s13, s23
    s_addk_i32 s57, 8192
    buffer_load_dwordx4 v[84:87], v20, s[36:39], s57 offen nt
    s_addk_i32 s57, 8192
    buffer_load_dwordx4 v[88:91], v20, s[36:39], s57 offen nt
    s_addk_i32 s57, 8192
    buffer_load_dwordx4 v[92:95], v20, s[36:39], s57 offen nt
    s_addk_i32 s57, 8192
    buffer_load_dwordx4 v[96:99], v20, s[36:39], s57 offen nt
    s_addk_i32 s57, 8192
    buffer_load_dwordx4 v[100:103], v20, s[36:39], s57 offen nt
    s_addk_i32 s57, 8192
    buffer_load_dwordx4 v[104:107], v20, s[36:39], s57 offen nt
    s_addk_i32 s57, 8192
    buffer_load_dwordx4 v[108:111], v20, s[36:39], s57 offen nt
    s_lshl_b32 s56, s56, 5
    v_lshl_add_u32 v21, v19, 4, s56
    v_bfe_u32 v19, v0, 3, 1
    v_lshl_add_u32 v21, v19, 10, v21
    global_load_dwordx4 v[4:7], v21, s[30:31]
    global_load_dwordx4 v[12:15], v21, s[30:31] offset:2048
    s_setprio 1
    v_lshrrev_b32 v17, 6, v0
    v_and_b32 v18, 63, v0
    v_readfirstlane_b32 s3, v17
    s_bfe_u32 s44, s2, 0x30003
    s_lshr_b32 s46, s44, 1
    s_and_b32 s47, s44, 1
    s_mov_b32 s34, 0x10000000
    s_mov_b32 s35, 0x20000
    s_mov_b32 s42, 0x400000
    s_mov_b32 s43, 0x20000
    v_mov_b32 v17, 0
    s_lshl_b32 s55, s46, 5
    s_add_u32 s55, s55, s45
    s_lshl1_add_u32 s81, s55, s47
    s_mul_i32 s55, s81, 1152
    s_add_u32 s55, s55, 1048576
    s_mov_b32 s36, s60
    s_mov_b32 s37, s61
    v_lshlrev_b32 v1, 4, v18
    v_bfe_u32 v19, v18, 3, 1
    v_xor_b32 v19, s47, v19
    v_mul_u32_u24 v19, 0x8100, v19
    v_xor_b32 v1, v1, v19
    v_xor_b32 v246, 0x8100, v1
    s_lshl_b32 s58, s3, 12
    s_bfe_u32 s56, s46, 65536
    s_lshl_b32 s56, s56, 10
    s_xor_b32 s58, s58, s56
    s_bfe_u32 s56, s46, 65537
    s_lshl_b32 s56, s56, 11
    s_xor_b32 s58, s58, s56
    s_and_b32 s56, s46, 1
    s_lshl1_add_u32 s56, s45, s56
    s_lshl_b32 s56, s56, 16
    s_add_u32 s48, s56, s58
    s_lshl_b32 s49, s81, 20
    s_add_u32 s49, s49, s58
    s_mul_i32 s56, s47, 786432
    s_sub_u32 s50, s49, s56
    s_add_u32 s50, s50, 1572864
    s_mov_b32 s32, s16
    s_mov_b32 s33, s17
    buffer_load_dwordx4 v[28:31], v1, s[36:39], s48 offen
    s_xor_b32 s57, s48, 9216
    buffer_load_dwordx4 v[32:35], v1, s[36:39], s57 offen
    s_xor_b32 s57, s48, 2048
    buffer_load_dwordx4 v[36:39], v1, s[36:39], s57 offen
    s_xor_b32 s57, s48, 11264
    buffer_load_dwordx4 v[40:43], v1, s[36:39], s57 offen
    s_xor_b32 s57, s48, 16384
    buffer_load_dwordx4 v[28:31], v1, s[36:39], s57 offen
    s_xor_b32 s57, s48, 25600
    buffer_load_dwordx4 v[32:35], v1, s[36:39], s57 offen
    s_xor_b32 s57, s48, 18432
    buffer_load_dwordx4 v[36:39], v1, s[36:39], s57 offen
    s_xor_b32 s57, s48, 27648
    buffer_load_dwordx4 v[40:43], v1, s[36:39], s57 offen
    s_mov_b32 s48, s50
    s_mov_b32 s40, s28
    s_mov_b32 s41, s29
    v_and_b32 v0, 1, v18
    v_lshlrev_b32 v0, 4, v0
    v_mov_b32 v19, 0xffff
    v_lshlrev_b32 v0, v0, v19
    v_bfe_u32 v19, v18, 1, 2
    v_cmp_eq_u32 vcc, 0, v19
    s_nop 1
    v_cndmask_b32 v8, 0, v0, vcc
    v_cmp_eq_u32 vcc, 1, v19
    s_nop 1
    v_cndmask_b32 v9, 0, v0, vcc
    v_cmp_eq_u32 vcc, 2, v19
    s_nop 1
    v_cndmask_b32 v10, 0, v0, vcc
    v_cmp_eq_u32 vcc, 3, v19
    s_nop 1
    v_cndmask_b32 v11, 0, v0, vcc
    s_mov_b32 s54, 0x3e0293ee
    s_mov_b32 s56, 0x01000100
    s_mov_b32 s58, 0x03020302
    s_waitcnt vmcnt(8)
    v_mov_b32 v20, 0
    v_mov_b32 v21, 0
    v_mov_b32 v22, 0
    v_mov_b32 v23, 0
    v_mov_b32 v24, 0
    v_mov_b32 v25, 0
    v_mov_b32 v26, 0
    v_mov_b32 v27, 0
    v_perm_b32 v0, v4, v4, s56
    v_and_b32 v176, v0, v8
    v_and_b32 v177, v0, v9
    v_and_b32 v178, v0, v10
    v_and_b32 v179, v0, v11
    v_perm_b32 v0, v12, v12, s56
    v_and_b32 v180, v0, v8
    v_and_b32 v181, v0, v9
    v_and_b32 v182, v0, v10
    v_and_b32 v183, v0, v11
    v_perm_b32 v0, v4, v4, s58
    v_and_b32 v184, v0, v8
    v_and_b32 v185, v0, v9
    v_and_b32 v186, v0, v10
    v_and_b32 v187, v0, v11
    v_perm_b32 v0, v12, v12, s58
    v_and_b32 v188, v0, v8
    v_and_b32 v189, v0, v9
    v_and_b32 v190, v0, v10
    v_and_b32 v191, v0, v11
    v_perm_b32 v0, v5, v5, s56
    v_and_b32 v192, v0, v8
    v_and_b32 v193, v0, v9
    v_and_b32 v194, v0, v10
    v_and_b32 v195, v0, v11
    v_perm_b32 v0, v13, v13, s56
    v_and_b32 v196, v0, v8
    v_and_b32 v197, v0, v9
    v_and_b32 v198, v0, v10
    v_and_b32 v199, v0, v11
    v_perm_b32 v0, v5, v5, s58
    v_and_b32 v200, v0, v8
    v_and_b32 v201, v0, v9
    v_and_b32 v202, v0, v10
    v_and_b32 v203, v0, v11
    v_perm_b32 v0, v13, v13, s58
    v_and_b32 v204, v0, v8
    v_and_b32 v205, v0, v9
    v_and_b32 v206, v0, v10
    v_and_b32 v207, v0, v11
    v_perm_b32 v0, v6, v6, s56
    v_and_b32 v208, v0, v8
    v_and_b32 v209, v0, v9
    v_and_b32 v210, v0, v10
    v_and_b32 v211, v0, v11
    v_perm_b32 v0, v14, v14, s56
    v_and_b32 v212, v0, v8
    v_and_b32 v213, v0, v9
    v_and_b32 v214, v0, v10
    v_and_b32 v215, v0, v11
    v_perm_b32 v0, v6, v6, s58
    v_and_b32 v216, v0, v8
    v_and_b32 v217, v0, v9
    v_and_b32 v218, v0, v10
    v_and_b32 v219, v0, v11
    v_perm_b32 v0, v14, v14, s58
    v_and_b32 v220, v0, v8
    v_and_b32 v221, v0, v9
    v_and_b32 v222, v0, v10
    v_and_b32 v223, v0, v11
    v_perm_b32 v0, v7, v7, s56
    v_and_b32 v224, v0, v8
    v_and_b32 v225, v0, v9
    v_and_b32 v226, v0, v10
    v_and_b32 v227, v0, v11
    v_perm_b32 v0, v15, v15, s56
    v_and_b32 v228, v0, v8
    v_and_b32 v229, v0, v9
    v_and_b32 v230, v0, v10
    v_and_b32 v231, v0, v11
    v_perm_b32 v0, v7, v7, s58
    v_and_b32 v232, v0, v8
    v_and_b32 v233, v0, v9
    v_and_b32 v234, v0, v10
    v_and_b32 v235, v0, v11
    v_perm_b32 v0, v15, v15, s58
    v_and_b32 v236, v0, v8
    v_and_b32 v237, v0, v9
    v_and_b32 v238, v0, v10
    v_and_b32 v239, v0, v11
    s_waitcnt vmcnt(17)
    v_mfma_f32_16x16x32_bf16 v[20:23], v[176:179], v[80:83], v[20:23]
    v_mfma_f32_16x16x32_bf16 v[24:27], v[180:183], v[80:83], v[24:27]
    s_waitcnt vmcnt(16)
    v_mfma_f32_16x16x32_bf16 v[20:23], v[184:187], v[84:87], v[20:23]
    v_mfma_f32_16x16x32_bf16 v[24:27], v[188:191], v[84:87], v[24:27]
    s_waitcnt vmcnt(15)
    v_mfma_f32_16x16x32_bf16 v[20:23], v[192:195], v[88:91], v[20:23]
    v_mfma_f32_16x16x32_bf16 v[24:27], v[196:199], v[88:91], v[24:27]
    s_waitcnt vmcnt(14)
    v_mfma_f32_16x16x32_bf16 v[20:23], v[200:203], v[92:95], v[20:23]
    v_mfma_f32_16x16x32_bf16 v[24:27], v[204:207], v[92:95], v[24:27]
    s_waitcnt vmcnt(13)
    v_mfma_f32_16x16x32_bf16 v[20:23], v[208:211], v[96:99], v[20:23]
    v_mfma_f32_16x16x32_bf16 v[24:27], v[212:215], v[96:99], v[24:27]
    s_waitcnt vmcnt(12)
    v_mfma_f32_16x16x32_bf16 v[20:23], v[216:219], v[100:103], v[20:23]
    v_mfma_f32_16x16x32_bf16 v[24:27], v[220:223], v[100:103], v[24:27]
    s_waitcnt vmcnt(11)
    v_mfma_f32_16x16x32_bf16 v[20:23], v[224:227], v[104:107], v[20:23]
    v_mfma_f32_16x16x32_bf16 v[24:27], v[228:231], v[104:107], v[24:27]
    s_waitcnt vmcnt(10)
    v_mfma_f32_16x16x32_bf16 v[20:23], v[232:235], v[108:111], v[20:23]
    v_mfma_f32_16x16x32_bf16 v[24:27], v[236:239], v[108:111], v[24:27]
    v_and_b32 v0, 15, v18
    v_lshlrev_b32 v0, 5, v0
    v_and_b32 v19, 16, v18
    v_add_u32 v0, v0, v19
    v_lshrrev_b32 v19, 5, v18
    v_lshl_add_u32 v0, v19, 9, v0
    s_lshl_b32 s56, s3, 11
    v_add_u32 v0, s56, v0
    s_nop 1
    ds_write_b128 v0, v[20:23] offset:0
    ds_write_b128 v0, v[24:27] offset:1024
    s_waitcnt lgkmcnt(0)
    s_barrier
    s_waitcnt vmcnt(5)
    buffer_load_dwordx4 v[112:115], v1, s[32:35], s48 offen nt
    s_xor_b32 s57, s48, 9216
    buffer_load_dwordx4 v[116:119], v1, s[32:35], s57 offen nt
    s_waitcnt vmcnt(5)
    s_xor_b32 s57, s48, 2048
    buffer_load_dwordx4 v[120:123], v1, s[32:35], s57 offen nt
    s_xor_b32 s57, s48, 11264
    buffer_load_dwordx4 v[124:127], v1, s[32:35], s57 offen nt
    v_lshlrev_b32 v240, 3, v18
    v_lshrrev_b32 v0, 3, v18
    v_lshlrev_b32 v241, 6, v0
    v_and_b32 v0, 1, v0
    v_lshrrev_b32 v19, 5, v18
    v_lshl_add_u32 v0, v19, 1, v0
    v_mul_u32_u24 v245, 16512, v0
    v_bfe_u32 v0, v18, 4, 1
    v_lshl_add_u32 v245, v0, 10, v245
    v_bfe_i32 v249, v18, 2, 1
    v_not_b32 v248, v249
    v_and_b32 v250, 3, v18
    v_mul_u32_u24 v250, 0x5555, v250
    v_and_b32 v19, 7, v18
    v_lshl_add_u32 v245, v19, 4, v245
    v_lshlrev_b32 v242, 3, v19
    v_lshrrev_b32 v0, 4, v18
    v_lshl_add_u32 v242, v0, 6, v242
    v_and_b32 v19, 16, v18
    s_lshl_b32 s56, s3, 8
    v_add_u32 v245, s56, v245
    s_lshl_b32 s56, s3, 8
    v_add_u32 v242, s56, v242
    s_lshl_b32 s56, s3, 9
    v_and_b32 v0, 15, v18
    v_lshlrev_b32 v0, 5, v0
    v_add3_u32 v243, v0, v19, s56
    v_add_u32 v251, 66048, v245
    s_waitcnt vmcnt(5)
    s_xor_b32 s57, s48, 16384
    buffer_load_dwordx4 v[128:131], v1, s[32:35], s57 offen nt
    s_xor_b32 s57, s48, 25600
    buffer_load_dwordx4 v[132:135], v1, s[32:35], s57 offen nt
    s_waitcnt vmcnt(5)
    s_xor_b32 s57, s48, 18432
    buffer_load_dwordx4 v[136:139], v1, s[32:35], s57 offen nt
    s_xor_b32 s57, s48, 27648
    buffer_load_dwordx4 v[140:143], v1, s[32:35], s57 offen nt
    s_lshl_b32 s80, s3, 12
    v_and_b32 v45, 60, v18
    v_add_u32 v45, s80, v45
    v_mov_b32 v44, 0xff7fffff
    s_and_b32 s63, s2, 7
    s_lshr_b32 s56, s2, 3
    s_and_b32 s52, s63, 1
    s_lshl_b32 s52, s52, 2
    s_lshr_b32 s58, s63, 1
    s_add_u32 s52, s52, s58
    s_mul_i32 s52, s52, 73728
    s_add_u32 s52, s52, 1048576
    s_lshl_b32 s56, s56, 2
    s_add_u32 s56, s56, s3
    s_lshl_b32 s58, s56, 3
    s_add_u32 s81, s52, s58
    s_and_b32 s58, s56, 7
    s_bfe_u32 s59, s56, 0x10003
    s_lshl1_add_u32 s58, s58, s59
    s_andn2_b32 s56, s56, 15
    s_add_u32 s56, s56, s58
    s_lshl_b32 s56, s56, 3
    s_lshl_b32 s63, s63, 10
    s_add_u32 s63, s63, s56
    v_mul_u32_u24 v244, 1152, v18
    s_waitcnt vmcnt(5)
    buffer_load_dwordx4 v[144:147], v246, s[32:35], s48 offen nt
    s_xor_b32 s57, s48, 9216
    buffer_load_dwordx4 v[148:151], v246, s[32:35], s57 offen nt
    s_waitcnt vmcnt(5)
    s_xor_b32 s57, s48, 2048
    buffer_load_dwordx4 v[152:155], v246, s[32:35], s57 offen nt
    s_xor_b32 s57, s48, 11264
    buffer_load_dwordx4 v[156:159], v246, s[32:35], s57 offen nt
    s_waitcnt vmcnt(5)
    s_xor_b32 s57, s48, 16384
    buffer_load_dwordx4 v[160:163], v246, s[32:35], s57 offen nt
    s_xor_b32 s57, s48, 25600
    buffer_load_dwordx4 v[164:167], v246, s[32:35], s57 offen nt
    s_waitcnt vmcnt(5)
    s_xor_b32 s57, s48, 18432
    buffer_load_dwordx4 v[168:171], v246, s[32:35], s57 offen nt
    s_xor_b32 s57, s48, 27648
    buffer_load_dwordx4 v[172:175], v246, s[32:35], s57 offen nt
    s_add_u32 s48, s48, 0x10000
    s_waitcnt vmcnt(5)
    buffer_load_dwordx4 v[48:51], v1, s[32:35], s48 offen nt
    s_xor_b32 s57, s48, 9216
    buffer_load_dwordx4 v[52:55], v1, s[32:35], s57 offen nt
    s_waitcnt vmcnt(5)
    s_xor_b32 s57, s48, 2048
    buffer_load_dwordx4 v[56:59], v1, s[32:35], s57 offen nt
    s_xor_b32 s57, s48, 11264
    buffer_load_dwordx4 v[60:63], v1, s[32:35], s57 offen nt
    s_waitcnt vmcnt(5)
    s_xor_b32 s57, s48, 16384
    buffer_load_dwordx4 v[64:67], v1, s[32:35], s57 offen nt
    s_xor_b32 s57, s48, 25600
    buffer_load_dwordx4 v[68:71], v1, s[32:35], s57 offen nt
    s_waitcnt vmcnt(5)
    s_xor_b32 s57, s48, 18432
    buffer_load_dwordx4 v[72:75], v1, s[32:35], s57 offen nt
    s_xor_b32 s57, s48, 27648
    buffer_load_dwordx4 v[76:79], v1, s[32:35], s57 offen nt
    s_waitcnt vmcnt(5)
    buffer_load_dwordx4 v[80:83], v246, s[32:35], s48 offen nt
    s_xor_b32 s57, s48, 9216
    buffer_load_dwordx4 v[84:87], v246, s[32:35], s57 offen nt
    s_waitcnt vmcnt(5)
    s_xor_b32 s57, s48, 2048
    buffer_load_dwordx4 v[88:91], v246, s[32:35], s57 offen nt
    s_xor_b32 s57, s48, 11264
    buffer_load_dwordx4 v[92:95], v246, s[32:35], s57 offen nt
    s_waitcnt vmcnt(5)
    s_xor_b32 s57, s48, 16384
    buffer_load_dwordx4 v[96:99], v246, s[32:35], s57 offen nt
    s_xor_b32 s57, s48, 25600
    buffer_load_dwordx4 v[100:103], v246, s[32:35], s57 offen nt
    s_waitcnt vmcnt(5)
    s_xor_b32 s57, s48, 18432
    buffer_load_dwordx4 v[104:107], v246, s[32:35], s57 offen nt
    s_xor_b32 s57, s48, 27648
    buffer_load_dwordx4 v[108:111], v246, s[32:35], s57 offen nt
    s_add_u32 s48, s48, 0x10000
    s_waitcnt vmcnt(5)
    buffer_load_dwordx4 v[176:179], v1, s[32:35], s48 offen nt
    s_xor_b32 s57, s48, 9216
    buffer_load_dwordx4 v[180:183], v1, s[32:35], s57 offen nt
    s_waitcnt vmcnt(5)
    s_xor_b32 s57, s48, 2048
    buffer_load_dwordx4 v[184:187], v1, s[32:35], s57 offen nt
    s_xor_b32 s57, s48, 11264
    buffer_load_dwordx4 v[188:191], v1, s[32:35], s57 offen nt
    s_waitcnt vmcnt(5)
    s_xor_b32 s57, s48, 16384
    buffer_load_dwordx4 v[192:195], v1, s[32:35], s57 offen nt
    s_xor_b32 s57, s48, 25600
    buffer_load_dwordx4 v[196:199], v1, s[32:35], s57 offen nt
    s_waitcnt vmcnt(5)
    s_xor_b32 s57, s48, 18432
    buffer_load_dwordx4 v[200:203], v1, s[32:35], s57 offen nt
    s_xor_b32 s57, s48, 27648
    buffer_load_dwordx4 v[204:207], v1, s[32:35], s57 offen nt
    s_waitcnt vmcnt(5)
    buffer_load_dwordx4 v[208:211], v246, s[32:35], s48 offen nt
    s_xor_b32 s57, s48, 9216
    buffer_load_dwordx4 v[212:215], v246, s[32:35], s57 offen nt
    s_waitcnt vmcnt(5)
    s_xor_b32 s57, s48, 2048
    buffer_load_dwordx4 v[216:219], v246, s[32:35], s57 offen nt
    s_xor_b32 s57, s48, 11264
    buffer_load_dwordx4 v[220:223], v246, s[32:35], s57 offen nt
    s_waitcnt vmcnt(5)
    s_xor_b32 s57, s48, 16384
    buffer_load_dwordx4 v[224:227], v246, s[32:35], s57 offen nt
    s_xor_b32 s57, s48, 25600
    buffer_load_dwordx4 v[228:231], v246, s[32:35], s57 offen nt
    s_waitcnt vmcnt(5)
    s_xor_b32 s57, s48, 18432
    buffer_load_dwordx4 v[232:235], v246, s[32:35], s57 offen nt
    s_xor_b32 s57, s48, 27648
    buffer_load_dwordx4 v[236:239], v246, s[32:35], s57 offen nt
    s_add_u32 s48, s48, 0x10000
    v_and_b32 v19, 15, v18
    v_lshlrev_b32 v19, 4, v19
    s_barrier
    ds_read_b128 v[4:7], v19 offset:8448
    ds_read_b32 v0, v17 offset:8704
    s_waitcnt lgkmcnt(0)
    v_readfirstlane_b32 s78, v0
    s_waitcnt vmcnt(12)
    v_dot2_f32_bf16 v20, v112, v4, 0
    v_dot2_f32_bf16 v21, v116, v4, 0
    v_dot2_f32_bf16 v22, v120, v4, 0
    v_dot2_f32_bf16 v23, v124, v4, 0
    v_dot2_f32_bf16 v20, v113, v5, v20
    v_dot2_f32_bf16 v21, v117, v5, v21
    v_dot2_f32_bf16 v22, v121, v5, v22
    v_dot2_f32_bf16 v23, v125, v5, v23
    v_dot2_f32_bf16 v20, v114, v6, v20
    v_dot2_f32_bf16 v21, v118, v6, v21
    v_dot2_f32_bf16 v22, v122, v6, v22
    v_dot2_f32_bf16 v23, v126, v6, v23
    v_dot2_f32_bf16 v20, v115, v7, v20
    v_dot2_f32_bf16 v21, v119, v7, v21
    v_dot2_f32_bf16 v22, v123, v7, v22
    v_dot2_f32_bf16 v23, v127, v7, v23
    s_bitcmp1_b32 s78, 24
    s_cbranch_scc1 L_t1
    s_waitcnt vmcnt(9)
    s_bitcmp1_b32 s78, 16
    s_cbranch_scc1 L_t1
    s_waitcnt vmcnt(6)
    s_bitcmp1_b32 s78, 8
    s_cbranch_scc1 L_t1
    s_bitcmp1_b32 s78, 0
    s_cbranch_scc1 L_u1
    s_waitcnt vmcnt(3)
L_u1:
    s_waitcnt vmcnt(4)
L_t1:
    buffer_load_dwordx4 v[112:115], v1, s[32:35], s48 offen nt
    s_bitcmp1_b32 s78, 25
    s_cbranch_scc1 L_t2
    s_waitcnt vmcnt(9)
    s_bitcmp1_b32 s78, 17
    s_cbranch_scc1 L_t2
    s_waitcnt vmcnt(6)
    s_bitcmp1_b32 s78, 9
    s_cbranch_scc1 L_t2
    s_bitcmp1_b32 s78, 1
    s_cbranch_scc1 L_u2
    s_waitcnt vmcnt(3)
L_u2:
    s_waitcnt vmcnt(4)
L_t2:
    s_xor_b32 s57, s48, 9216
    buffer_load_dwordx4 v[116:119], v1, s[32:35], s57 offen nt
    s_waitcnt vmcnt(12)
    v_dot2_f32_bf16 v24, v128, v4, 0
    v_dot2_f32_bf16 v25, v132, v4, 0
    v_dot2_f32_bf16 v26, v136, v4, 0
    v_dot2_f32_bf16 v27, v140, v4, 0
    v_dot2_f32_bf16 v24, v129, v5, v24
    v_dot2_f32_bf16 v25, v133, v5, v25
    v_dot2_f32_bf16 v26, v137, v5, v26
    v_dot2_f32_bf16 v27, v141, v5, v27
    v_dot2_f32_bf16 v24, v130, v6, v24
    v_dot2_f32_bf16 v25, v134, v6, v25
    v_dot2_f32_bf16 v26, v138, v6, v26
    v_dot2_f32_bf16 v27, v142, v6, v27
    v_dot2_f32_bf16 v24, v131, v7, v24
    v_dot2_f32_bf16 v25, v135, v7, v25
    v_dot2_f32_bf16 v26, v139, v7, v26
    v_dot2_f32_bf16 v27, v143, v7, v27
    s_bitcmp1_b32 s78, 26
    s_cbranch_scc1 L_t3
    s_waitcnt vmcnt(9)
    s_bitcmp1_b32 s78, 18
    s_cbranch_scc1 L_t3
    s_waitcnt vmcnt(6)
    s_bitcmp1_b32 s78, 10
    s_cbranch_scc1 L_t3
    s_bitcmp1_b32 s78, 2
    s_cbranch_scc1 L_u3
    s_waitcnt vmcnt(3)
L_u3:
    s_waitcnt vmcnt(4)
L_t3:
    s_xor_b32 s57, s48, 2048
    buffer_load_dwordx4 v[120:123], v1, s[32:35], s57 offen nt
    s_bitcmp1_b32 s78, 27
    s_cbranch_scc1 L_t4
    s_waitcnt vmcnt(9)
    s_bitcmp1_b32 s78, 19
    s_cbranch_scc1 L_t4
    s_waitcnt vmcnt(6)
    s_bitcmp1_b32 s78, 11
    s_cbranch_scc1 L_t4
    s_bitcmp1_b32 s78, 3
    s_cbranch_scc1 L_u4
    s_waitcnt vmcnt(3)
L_u4:
    s_waitcnt vmcnt(4)
L_t4:
    s_xor_b32 s57, s48, 11264
    buffer_load_dwordx4 v[124:127], v1, s[32:35], s57 offen nt
    s_waitcnt vmcnt(12)
    v_dot2_f32_bf16 v28, v144, v4, 0
    v_dot2_f32_bf16 v29, v148, v4, 0
    v_dot2_f32_bf16 v30, v152, v4, 0
    v_dot2_f32_bf16 v31, v156, v4, 0
    v_dot2_f32_bf16 v28, v145, v5, v28
    v_dot2_f32_bf16 v29, v149, v5, v29
    v_dot2_f32_bf16 v30, v153, v5, v30
    v_dot2_f32_bf16 v31, v157, v5, v31
    v_dot2_f32_bf16 v28, v146, v6, v28
    v_dot2_f32_bf16 v29, v150, v6, v29
    v_dot2_f32_bf16 v30, v154, v6, v30
    v_dot2_f32_bf16 v31, v158, v6, v31
    v_dot2_f32_bf16 v28, v147, v7, v28
    v_dot2_f32_bf16 v29, v151, v7, v29
    v_dot2_f32_bf16 v30, v155, v7, v30
    v_dot2_f32_bf16 v31, v159, v7, v31
    s_bitcmp1_b32 s78, 28
    s_cbranch_scc1 L_t5
    s_waitcnt vmcnt(9)
    s_bitcmp1_b32 s78, 20
    s_cbranch_scc1 L_t5
    s_waitcnt vmcnt(6)
    s_bitcmp1_b32 s78, 12
    s_cbranch_scc1 L_t5
    s_bitcmp1_b32 s78, 4
    s_cbranch_scc1 L_u5
    s_waitcnt vmcnt(3)
L_u5:
    s_waitcnt vmcnt(4)
L_t5:
    s_xor_b32 s57, s48, 16384
    buffer_load_dwordx4 v[128:131], v1, s[32:35], s57 offen nt
    s_bitcmp1_b32 s78, 29
    s_cbranch_scc1 L_t6
    s_waitcnt vmcnt(9)
    s_bitcmp1_b32 s78, 21
    s_cbranch_scc1 L_t6
    s_waitcnt vmcnt(6)
    s_bitcmp1_b32 s78, 13
    s_cbranch_scc1 L_t6
    s_bitcmp1_b32 s78, 5
    s_cbranch_scc1 L_u6
    s_waitcnt vmcnt(3)
L_u6:
    s_waitcnt vmcnt(4)
L_t6:
    s_xor_b32 s57, s48, 25600
    buffer_load_dwordx4 v[132:135], v1, s[32:35], s57 offen nt
    v_add_f32_dpp v20, v28, v20 row_ror:8 row_mask:0xf bank_mask:0xf
    v_add_f32_dpp v21, v29, v21 row_ror:8 row_mask:0xf bank_mask:0xf
    v_add_f32_dpp v22, v30, v22 row_ror:8 row_mask:0xf bank_mask:0xf
    v_add_f32_dpp v23, v31, v23 row_ror:8 row_mask:0xf bank_mask:0xf
    v_add_f32_dpp v20, v20, v20 row_half_mirror row_mask:0xf bank_mask:0x5
    v_add_f32_dpp v20, v21, v21 row_half_mirror row_mask:0xf bank_mask:0xa
    v_add_f32_dpp v22, v22, v22 row_half_mirror row_mask:0xf bank_mask:0x5
    v_add_f32_dpp v22, v23, v23 row_half_mirror row_mask:0xf bank_mask:0xa
    v_add_f32_dpp v20, v20, v20 quad_perm:[1,0,3,2] row_mask:0xf bank_mask:0xf
    s_nop 0
    v_add_f32_dpp v22, v22, v22 quad_perm:[1,0,3,2] row_mask:0xf bank_mask:0xf
    v_add_f32_dpp v20, v20, v20 quad_perm:[2,3,0,1] row_mask:0xf bank_mask:0xf
    s_nop 0
    v_add_f32_dpp v22, v22, v22 quad_perm:[2,3,0,1] row_mask:0xf bank_mask:0xf
    ds_write_b32 v45, v20 offset:9216
    v_max3_f32 v44, v44, v20, v22
    ds_write_b32 v45, v22 offset:9280
    s_waitcnt vmcnt(12)
    v_dot2_f32_bf16 v32, v160, v4, 0
    v_dot2_f32_bf16 v33, v164, v4, 0
    v_dot2_f32_bf16 v34, v168, v4, 0
    v_dot2_f32_bf16 v35, v172, v4, 0
    v_dot2_f32_bf16 v32, v161, v5, v32
    v_dot2_f32_bf16 v33, v165, v5, v33
    v_dot2_f32_bf16 v34, v169, v5, v34
    v_dot2_f32_bf16 v35, v173, v5, v35
    v_dot2_f32_bf16 v32, v162, v6, v32
    v_dot2_f32_bf16 v33, v166, v6, v33
    v_dot2_f32_bf16 v34, v170, v6, v34
    v_dot2_f32_bf16 v35, v174, v6, v35
    v_dot2_f32_bf16 v32, v163, v7, v32
    v_dot2_f32_bf16 v33, v167, v7, v33
    v_dot2_f32_bf16 v34, v171, v7, v34
    v_dot2_f32_bf16 v35, v175, v7, v35
    s_bitcmp1_b32 s78, 30
    s_cbranch_scc1 L_t7
    s_waitcnt vmcnt(9)
    s_bitcmp1_b32 s78, 22
    s_cbranch_scc1 L_t7
    s_waitcnt vmcnt(6)
    s_bitcmp1_b32 s78, 14
    s_cbranch_scc1 L_t7
    s_bitcmp1_b32 s78, 6
    s_cbranch_scc1 L_u7
    s_waitcnt vmcnt(3)
L_u7:
    s_waitcnt vmcnt(4)
L_t7:
    s_xor_b32 s57, s48, 18432
    buffer_load_dwordx4 v[136:139], v1, s[32:35], s57 offen nt
    s_bitcmp1_b32 s78, 31
    s_cbranch_scc1 L_t8
    s_waitcnt vmcnt(9)
    s_bitcmp1_b32 s78, 23
    s_cbranch_scc1 L_t8
    s_waitcnt vmcnt(6)
    s_bitcmp1_b32 s78, 15
    s_cbranch_scc1 L_t8
    s_bitcmp1_b32 s78, 7
    s_cbranch_scc1 L_u8
    s_waitcnt vmcnt(3)
L_u8:
    s_waitcnt vmcnt(4)
L_t8:
    s_xor_b32 s57, s48, 27648
    buffer_load_dwordx4 v[140:143], v1, s[32:35], s57 offen nt
    v_add_f32_dpp v24, v32, v24 row_ror:8 row_mask:0xf bank_mask:0xf
    v_add_f32_dpp v25, v33, v25 row_ror:8 row_mask:0xf bank_mask:0xf
    v_add_f32_dpp v26, v34, v26 row_ror:8 row_mask:0xf bank_mask:0xf
    v_add_f32_dpp v27, v35, v27 row_ror:8 row_mask:0xf bank_mask:0xf
    v_add_f32_dpp v24, v24, v24 row_half_mirror row_mask:0xf bank_mask:0x5
    v_add_f32_dpp v24, v25, v25 row_half_mirror row_mask:0xf bank_mask:0xa
    v_add_f32_dpp v26, v26, v26 row_half_mirror row_mask:0xf bank_mask:0x5
    v_add_f32_dpp v26, v27, v27 row_half_mirror row_mask:0xf bank_mask:0xa
    v_add_f32_dpp v24, v24, v24 quad_perm:[1,0,3,2] row_mask:0xf bank_mask:0xf
    s_nop 0
    v_add_f32_dpp v26, v26, v26 quad_perm:[1,0,3,2] row_mask:0xf bank_mask:0xf
    v_add_f32_dpp v24, v24, v24 quad_perm:[2,3,0,1] row_mask:0xf bank_mask:0xf
    s_nop 0
    v_add_f32_dpp v26, v26, v26 quad_perm:[2,3,0,1] row_mask:0xf bank_mask:0xf
    ds_write_b32 v45, v24 offset:9344
    v_max3_f32 v44, v44, v24, v26
    ds_write_b32 v45, v26 offset:9408
    s_barrier
    ds_read_b32 v0, v17 offset:8704
    s_waitcnt lgkmcnt(0)
    v_readfirstlane_b32 s78, v0
    s_waitcnt vmcnt(12)
    v_dot2_f32_bf16 v20, v48, v4, 0
    v_dot2_f32_bf16 v21, v52, v4, 0
    v_dot2_f32_bf16 v22, v56, v4, 0
    v_dot2_f32_bf16 v23, v60, v4, 0
    v_dot2_f32_bf16 v20, v49, v5, v20
    v_dot2_f32_bf16 v21, v53, v5, v21
    v_dot2_f32_bf16 v22, v57, v5, v22
    v_dot2_f32_bf16 v23, v61, v5, v23
    v_dot2_f32_bf16 v20, v50, v6, v20
    v_dot2_f32_bf16 v21, v54, v6, v21
    v_dot2_f32_bf16 v22, v58, v6, v22
    v_dot2_f32_bf16 v23, v62, v6, v23
    v_dot2_f32_bf16 v20, v51, v7, v20
    v_dot2_f32_bf16 v21, v55, v7, v21
    v_dot2_f32_bf16 v22, v59, v7, v22
    v_dot2_f32_bf16 v23, v63, v7, v23
    s_bitcmp1_b32 s78, 24
    s_cbranch_scc1 L_t9
    s_waitcnt vmcnt(9)
    s_bitcmp1_b32 s78, 16
    s_cbranch_scc1 L_t9
    s_waitcnt vmcnt(6)
    s_bitcmp1_b32 s78, 8
    s_cbranch_scc1 L_t9
    s_bitcmp1_b32 s78, 0
    s_cbranch_scc1 L_u9
    s_waitcnt vmcnt(3)
L_u9:
    s_waitcnt vmcnt(4)
L_t9:
    buffer_load_dwordx4 v[144:147], v246, s[32:35], s48 offen nt
    s_bitcmp1_b32 s78, 25
    s_cbranch_scc1 L_t10
    s_waitcnt vmcnt(9)
    s_bitcmp1_b32 s78, 17
    s_cbranch_scc1 L_t10
    s_waitcnt vmcnt(6)
    s_bitcmp1_b32 s78, 9
    s_cbranch_scc1 L_t10
    s_bitcmp1_b32 s78, 1
    s_cbranch_scc1 L_u10
    s_waitcnt vmcnt(3)
L_u10:
    s_waitcnt vmcnt(4)
L_t10:
    s_xor_b32 s57, s48, 9216
    buffer_load_dwordx4 v[148:151], v246, s[32:35], s57 offen nt
    s_waitcnt vmcnt(12)
    v_dot2_f32_bf16 v24, v64, v4, 0
    v_dot2_f32_bf16 v25, v68, v4, 0
    v_dot2_f32_bf16 v26, v72, v4, 0
    v_dot2_f32_bf16 v27, v76, v4, 0
    v_dot2_f32_bf16 v24, v65, v5, v24
    v_dot2_f32_bf16 v25, v69, v5, v25
    v_dot2_f32_bf16 v26, v73, v5, v26
    v_dot2_f32_bf16 v27, v77, v5, v27
    v_dot2_f32_bf16 v24, v66, v6, v24
    v_dot2_f32_bf16 v25, v70, v6, v25
    v_dot2_f32_bf16 v26, v74, v6, v26
    v_dot2_f32_bf16 v27, v78, v6, v27
    v_dot2_f32_bf16 v24, v67, v7, v24
    v_dot2_f32_bf16 v25, v71, v7, v25
    v_dot2_f32_bf16 v26, v75, v7, v26
    v_dot2_f32_bf16 v27, v79, v7, v27
    s_bitcmp1_b32 s78, 26
    s_cbranch_scc1 L_t11
    s_waitcnt vmcnt(9)
    s_bitcmp1_b32 s78, 18
    s_cbranch_scc1 L_t11
    s_waitcnt vmcnt(6)
    s_bitcmp1_b32 s78, 10
    s_cbranch_scc1 L_t11
    s_bitcmp1_b32 s78, 2
    s_cbranch_scc1 L_u11
    s_waitcnt vmcnt(3)
L_u11:
    s_waitcnt vmcnt(4)
L_t11:
    s_xor_b32 s57, s48, 2048
    buffer_load_dwordx4 v[152:155], v246, s[32:35], s57 offen nt
    s_bitcmp1_b32 s78, 27
    s_cbranch_scc1 L_t12
    s_waitcnt vmcnt(9)
    s_bitcmp1_b32 s78, 19
    s_cbranch_scc1 L_t12
    s_waitcnt vmcnt(6)
    s_bitcmp1_b32 s78, 11
    s_cbranch_scc1 L_t12
    s_bitcmp1_b32 s78, 3
    s_cbranch_scc1 L_u12
    s_waitcnt vmcnt(3)
L_u12:
    s_waitcnt vmcnt(4)
L_t12:
    s_xor_b32 s57, s48, 11264
    buffer_load_dwordx4 v[156:159], v246, s[32:35], s57 offen nt
    s_waitcnt vmcnt(12)
    v_dot2_f32_bf16 v28, v80, v4, 0
    v_dot2_f32_bf16 v29, v84, v4, 0
    v_dot2_f32_bf16 v30, v88, v4, 0
    v_dot2_f32_bf16 v31, v92, v4, 0
    v_dot2_f32_bf16 v28, v81, v5, v28
    v_dot2_f32_bf16 v29, v85, v5, v29
    v_dot2_f32_bf16 v30, v89, v5, v30
    v_dot2_f32_bf16 v31, v93, v5, v31
    v_dot2_f32_bf16 v28, v82, v6, v28
    v_dot2_f32_bf16 v29, v86, v6, v29
    v_dot2_f32_bf16 v30, v90, v6, v30
    v_dot2_f32_bf16 v31, v94, v6, v31
    v_dot2_f32_bf16 v28, v83, v7, v28
    v_dot2_f32_bf16 v29, v87, v7, v29
    v_dot2_f32_bf16 v30, v91, v7, v30
    v_dot2_f32_bf16 v31, v95, v7, v31
    s_bitcmp1_b32 s78, 28
    s_cbranch_scc1 L_t13
    s_waitcnt vmcnt(9)
    s_bitcmp1_b32 s78, 20
    s_cbranch_scc1 L_t13
    s_waitcnt vmcnt(6)
    s_bitcmp1_b32 s78, 12
    s_cbranch_scc1 L_t13
    s_bitcmp1_b32 s78, 4
    s_cbranch_scc1 L_u13
    s_waitcnt vmcnt(3)
L_u13:
    s_waitcnt vmcnt(4)
L_t13:
    s_xor_b32 s57, s48, 16384
    buffer_load_dwordx4 v[160:163], v246, s[32:35], s57 offen nt
    s_bitcmp1_b32 s78, 29
    s_cbranch_scc1 L_t14
    s_waitcnt vmcnt(9)
    s_bitcmp1_b32 s78, 21
    s_cbranch_scc1 L_t14
    s_waitcnt vmcnt(6)
    s_bitcmp1_b32 s78, 13
    s_cbranch_scc1 L_t14
    s_bitcmp1_b32 s78, 5
    s_cbranch_scc1 L_u14
    s_waitcnt vmcnt(3)
L_u14:
    s_waitcnt vmcnt(4)
L_t14:
    s_xor_b32 s57, s48, 25600
    buffer_load_dwordx4 v[164:167], v246, s[32:35], s57 offen nt
    v_add_f32_dpp v20, v28, v20 row_ror:8 row_mask:0xf bank_mask:0xf
    v_add_f32_dpp v21, v29, v21 row_ror:8 row_mask:0xf bank_mask:0xf
    v_add_f32_dpp v22, v30, v22 row_ror:8 row_mask:0xf bank_mask:0xf
    v_add_f32_dpp v23, v31, v23 row_ror:8 row_mask:0xf bank_mask:0xf
    v_add_f32_dpp v20, v20, v20 row_half_mirror row_mask:0xf bank_mask:0x5
    v_add_f32_dpp v20, v21, v21 row_half_mirror row_mask:0xf bank_mask:0xa
    v_add_f32_dpp v22, v22, v22 row_half_mirror row_mask:0xf bank_mask:0x5
    v_add_f32_dpp v22, v23, v23 row_half_mirror row_mask:0xf bank_mask:0xa
    v_add_f32_dpp v20, v20, v20 quad_perm:[1,0,3,2] row_mask:0xf bank_mask:0xf
    s_nop 0
    v_add_f32_dpp v22, v22, v22 quad_perm:[1,0,3,2] row_mask:0xf bank_mask:0xf
    v_add_f32_dpp v20, v20, v20 quad_perm:[2,3,0,1] row_mask:0xf bank_mask:0xf
    s_nop 0
    v_add_f32_dpp v22, v22, v22 quad_perm:[2,3,0,1] row_mask:0xf bank_mask:0xf
    ds_write_b32 v45, v20 offset:9472
    v_max3_f32 v44, v44, v20, v22
    ds_write_b32 v45, v22 offset:9536
    s_waitcnt vmcnt(12)
    v_dot2_f32_bf16 v32, v96, v4, 0
    v_dot2_f32_bf16 v33, v100, v4, 0
    v_dot2_f32_bf16 v34, v104, v4, 0
    v_dot2_f32_bf16 v35, v108, v4, 0
    v_dot2_f32_bf16 v32, v97, v5, v32
    v_dot2_f32_bf16 v33, v101, v5, v33
    v_dot2_f32_bf16 v34, v105, v5, v34
    v_dot2_f32_bf16 v35, v109, v5, v35
    v_dot2_f32_bf16 v32, v98, v6, v32
    v_dot2_f32_bf16 v33, v102, v6, v33
    v_dot2_f32_bf16 v34, v106, v6, v34
    v_dot2_f32_bf16 v35, v110, v6, v35
    v_dot2_f32_bf16 v32, v99, v7, v32
    v_dot2_f32_bf16 v33, v103, v7, v33
    v_dot2_f32_bf16 v34, v107, v7, v34
    v_dot2_f32_bf16 v35, v111, v7, v35
    s_bitcmp1_b32 s78, 30
    s_cbranch_scc1 L_t15
    s_waitcnt vmcnt(9)
    s_bitcmp1_b32 s78, 22
    s_cbranch_scc1 L_t15
    s_waitcnt vmcnt(6)
    s_bitcmp1_b32 s78, 14
    s_cbranch_scc1 L_t15
    s_bitcmp1_b32 s78, 6
    s_cbranch_scc1 L_u15
    s_waitcnt vmcnt(3)
L_u15:
    s_waitcnt vmcnt(4)
L_t15:
    s_xor_b32 s57, s48, 18432
    buffer_load_dwordx4 v[168:171], v246, s[32:35], s57 offen nt
    s_bitcmp1_b32 s78, 31
    s_cbranch_scc1 L_t16
    s_waitcnt vmcnt(9)
    s_bitcmp1_b32 s78, 23
    s_cbranch_scc1 L_t16
    s_waitcnt vmcnt(6)
    s_bitcmp1_b32 s78, 15
    s_cbranch_scc1 L_t16
    s_bitcmp1_b32 s78, 7
    s_cbranch_scc1 L_u16
    s_waitcnt vmcnt(3)
L_u16:
    s_waitcnt vmcnt(4)
L_t16:
    s_xor_b32 s57, s48, 27648
    buffer_load_dwordx4 v[172:175], v246, s[32:35], s57 offen nt
    s_add_u32 s48, s48, 0x10000
    v_add_f32_dpp v24, v32, v24 row_ror:8 row_mask:0xf bank_mask:0xf
    v_add_f32_dpp v25, v33, v25 row_ror:8 row_mask:0xf bank_mask:0xf
    v_add_f32_dpp v26, v34, v26 row_ror:8 row_mask:0xf bank_mask:0xf
    v_add_f32_dpp v27, v35, v27 row_ror:8 row_mask:0xf bank_mask:0xf
    v_add_f32_dpp v24, v24, v24 row_half_mirror row_mask:0xf bank_mask:0x5
    v_add_f32_dpp v24, v25, v25 row_half_mirror row_mask:0xf bank_mask:0xa
    v_add_f32_dpp v26, v26, v26 row_half_mirror row_mask:0xf bank_mask:0x5
    v_add_f32_dpp v26, v27, v27 row_half_mirror row_mask:0xf bank_mask:0xa
    v_add_f32_dpp v24, v24, v24 quad_perm:[1,0,3,2] row_mask:0xf bank_mask:0xf
    s_nop 0
    v_add_f32_dpp v26, v26, v26 quad_perm:[1,0,3,2] row_mask:0xf bank_mask:0xf
    v_add_f32_dpp v24, v24, v24 quad_perm:[2,3,0,1] row_mask:0xf bank_mask:0xf
    s_nop 0
    v_add_f32_dpp v26, v26, v26 quad_perm:[2,3,0,1] row_mask:0xf bank_mask:0xf
    ds_write_b32 v45, v24 offset:9600
    v_max3_f32 v44, v44, v24, v26
    ds_write_b32 v45, v26 offset:9664
    s_barrier
    ds_read_b32 v0, v17 offset:8704
    s_waitcnt lgkmcnt(0)
    v_readfirstlane_b32 s78, v0
    s_mov_b32 s32, s18
    s_mov_b32 s33, s19
    s_mov_b32 s48, s50
    s_waitcnt vmcnt(12)
    v_dot2_f32_bf16 v20, v176, v4, 0
    v_dot2_f32_bf16 v21, v180, v4, 0
    v_dot2_f32_bf16 v22, v184, v4, 0
    v_dot2_f32_bf16 v23, v188, v4, 0
    v_dot2_f32_bf16 v20, v177, v5, v20
    v_dot2_f32_bf16 v21, v181, v5, v21
    v_dot2_f32_bf16 v22, v185, v5, v22
    v_dot2_f32_bf16 v23, v189, v5, v23
    v_dot2_f32_bf16 v20, v178, v6, v20
    v_dot2_f32_bf16 v21, v182, v6, v21
    v_dot2_f32_bf16 v22, v186, v6, v22
    v_dot2_f32_bf16 v23, v190, v6, v23
    v_dot2_f32_bf16 v20, v179, v7, v20
    v_dot2_f32_bf16 v21, v183, v7, v21
    v_dot2_f32_bf16 v22, v187, v7, v22
    v_dot2_f32_bf16 v23, v191, v7, v23
    s_bitcmp1_b32 s78, 24
    s_cbranch_scc1 L_t17
    s_waitcnt vmcnt(9)
    s_bitcmp1_b32 s78, 16
    s_cbranch_scc1 L_t17
    s_waitcnt vmcnt(6)
    s_bitcmp1_b32 s78, 8
    s_cbranch_scc1 L_t17
    s_bitcmp1_b32 s78, 0
    s_cbranch_scc1 L_u17
    s_waitcnt vmcnt(3)
L_u17:
    s_waitcnt vmcnt(4)
L_t17:
    buffer_load_dwordx4 v[48:51], v1, s[32:35], s48 offen nt
    s_bitcmp1_b32 s78, 25
    s_cbranch_scc1 L_t18
    s_waitcnt vmcnt(9)
    s_bitcmp1_b32 s78, 17
    s_cbranch_scc1 L_t18
    s_waitcnt vmcnt(6)
    s_bitcmp1_b32 s78, 9
    s_cbranch_scc1 L_t18
    s_bitcmp1_b32 s78, 1
    s_cbranch_scc1 L_u18
    s_waitcnt vmcnt(3)
L_u18:
    s_waitcnt vmcnt(4)
L_t18:
    s_xor_b32 s57, s48, 9216
    buffer_load_dwordx4 v[52:55], v1, s[32:35], s57 offen nt
    s_waitcnt vmcnt(12)
    v_dot2_f32_bf16 v24, v192, v4, 0
    v_dot2_f32_bf16 v25, v196, v4, 0
    v_dot2_f32_bf16 v26, v200, v4, 0
    v_dot2_f32_bf16 v27, v204, v4, 0
    v_dot2_f32_bf16 v24, v193, v5, v24
    v_dot2_f32_bf16 v25, v197, v5, v25
    v_dot2_f32_bf16 v26, v201, v5, v26
    v_dot2_f32_bf16 v27, v205, v5, v27
    v_dot2_f32_bf16 v24, v194, v6, v24
    v_dot2_f32_bf16 v25, v198, v6, v25
    v_dot2_f32_bf16 v26, v202, v6, v26
    v_dot2_f32_bf16 v27, v206, v6, v27
    v_dot2_f32_bf16 v24, v195, v7, v24
    v_dot2_f32_bf16 v25, v199, v7, v25
    v_dot2_f32_bf16 v26, v203, v7, v26
    v_dot2_f32_bf16 v27, v207, v7, v27
    s_bitcmp1_b32 s78, 26
    s_cbranch_scc1 L_t19
    s_waitcnt vmcnt(9)
    s_bitcmp1_b32 s78, 18
    s_cbranch_scc1 L_t19
    s_waitcnt vmcnt(6)
    s_bitcmp1_b32 s78, 10
    s_cbranch_scc1 L_t19
    s_bitcmp1_b32 s78, 2
    s_cbranch_scc1 L_u19
    s_waitcnt vmcnt(3)
L_u19:
    s_waitcnt vmcnt(4)
L_t19:
    s_xor_b32 s57, s48, 2048
    buffer_load_dwordx4 v[56:59], v1, s[32:35], s57 offen nt
    s_bitcmp1_b32 s78, 27
    s_cbranch_scc1 L_t20
    s_waitcnt vmcnt(9)
    s_bitcmp1_b32 s78, 19
    s_cbranch_scc1 L_t20
    s_waitcnt vmcnt(6)
    s_bitcmp1_b32 s78, 11
    s_cbranch_scc1 L_t20
    s_bitcmp1_b32 s78, 3
    s_cbranch_scc1 L_u20
    s_waitcnt vmcnt(3)
L_u20:
    s_waitcnt vmcnt(4)
L_t20:
    s_xor_b32 s57, s48, 11264
    buffer_load_dwordx4 v[60:63], v1, s[32:35], s57 offen nt
    s_waitcnt vmcnt(12)
    v_dot2_f32_bf16 v28, v208, v4, 0
    v_dot2_f32_bf16 v29, v212, v4, 0
    v_dot2_f32_bf16 v30, v216, v4, 0
    v_dot2_f32_bf16 v31, v220, v4, 0
    v_dot2_f32_bf16 v28, v209, v5, v28
    v_dot2_f32_bf16 v29, v213, v5, v29
    v_dot2_f32_bf16 v30, v217, v5, v30
    v_dot2_f32_bf16 v31, v221, v5, v31
    v_dot2_f32_bf16 v28, v210, v6, v28
    v_dot2_f32_bf16 v29, v214, v6, v29
    v_dot2_f32_bf16 v30, v218, v6, v30
    v_dot2_f32_bf16 v31, v222, v6, v31
    v_dot2_f32_bf16 v28, v211, v7, v28
    v_dot2_f32_bf16 v29, v215, v7, v29
    v_dot2_f32_bf16 v30, v219, v7, v30
    v_dot2_f32_bf16 v31, v223, v7, v31
    s_bitcmp1_b32 s78, 28
    s_cbranch_scc1 L_t21
    s_waitcnt vmcnt(9)
    s_bitcmp1_b32 s78, 20
    s_cbranch_scc1 L_t21
    s_waitcnt vmcnt(6)
    s_bitcmp1_b32 s78, 12
    s_cbranch_scc1 L_t21
    s_bitcmp1_b32 s78, 4
    s_cbranch_scc1 L_u21
    s_waitcnt vmcnt(3)
L_u21:
    s_waitcnt vmcnt(4)
L_t21:
    s_xor_b32 s57, s48, 16384
    buffer_load_dwordx4 v[64:67], v1, s[32:35], s57 offen nt
    s_bitcmp1_b32 s78, 29
    s_cbranch_scc1 L_t22
    s_waitcnt vmcnt(9)
    s_bitcmp1_b32 s78, 21
    s_cbranch_scc1 L_t22
    s_waitcnt vmcnt(6)
    s_bitcmp1_b32 s78, 13
    s_cbranch_scc1 L_t22
    s_bitcmp1_b32 s78, 5
    s_cbranch_scc1 L_u22
    s_waitcnt vmcnt(3)
L_u22:
    s_waitcnt vmcnt(4)
L_t22:
    s_xor_b32 s57, s48, 25600
    buffer_load_dwordx4 v[68:71], v1, s[32:35], s57 offen nt
    v_add_f32_dpp v20, v28, v20 row_ror:8 row_mask:0xf bank_mask:0xf
    v_add_f32_dpp v21, v29, v21 row_ror:8 row_mask:0xf bank_mask:0xf
    v_add_f32_dpp v22, v30, v22 row_ror:8 row_mask:0xf bank_mask:0xf
    v_add_f32_dpp v23, v31, v23 row_ror:8 row_mask:0xf bank_mask:0xf
    v_add_f32_dpp v20, v20, v20 row_half_mirror row_mask:0xf bank_mask:0x5
    v_add_f32_dpp v20, v21, v21 row_half_mirror row_mask:0xf bank_mask:0xa
    v_add_f32_dpp v22, v22, v22 row_half_mirror row_mask:0xf bank_mask:0x5
    v_add_f32_dpp v22, v23, v23 row_half_mirror row_mask:0xf bank_mask:0xa
    v_add_f32_dpp v20, v20, v20 quad_perm:[1,0,3,2] row_mask:0xf bank_mask:0xf
    s_nop 0
    v_add_f32_dpp v22, v22, v22 quad_perm:[1,0,3,2] row_mask:0xf bank_mask:0xf
    v_add_f32_dpp v20, v20, v20 quad_perm:[2,3,0,1] row_mask:0xf bank_mask:0xf
    s_nop 0
    v_add_f32_dpp v22, v22, v22 quad_perm:[2,3,0,1] row_mask:0xf bank_mask:0xf
    ds_write_b32 v45, v20 offset:9728
    v_max3_f32 v44, v44, v20, v22
    ds_write_b32 v45, v22 offset:9792
    s_waitcnt vmcnt(12)
    v_dot2_f32_bf16 v32, v224, v4, 0
    v_dot2_f32_bf16 v33, v228, v4, 0
    v_dot2_f32_bf16 v34, v232, v4, 0
    v_dot2_f32_bf16 v35, v236, v4, 0
    v_dot2_f32_bf16 v32, v225, v5, v32
    v_dot2_f32_bf16 v33, v229, v5, v33
    v_dot2_f32_bf16 v34, v233, v5, v34
    v_dot2_f32_bf16 v35, v237, v5, v35
    v_dot2_f32_bf16 v32, v226, v6, v32
    v_dot2_f32_bf16 v33, v230, v6, v33
    v_dot2_f32_bf16 v34, v234, v6, v34
    v_dot2_f32_bf16 v35, v238, v6, v35
    v_dot2_f32_bf16 v32, v227, v7, v32
    v_dot2_f32_bf16 v33, v231, v7, v33
    v_dot2_f32_bf16 v34, v235, v7, v34
    v_dot2_f32_bf16 v35, v239, v7, v35
    s_bitcmp1_b32 s78, 30
    s_cbranch_scc1 L_t23
    s_waitcnt vmcnt(9)
    s_bitcmp1_b32 s78, 22
    s_cbranch_scc1 L_t23
    s_waitcnt vmcnt(6)
    s_bitcmp1_b32 s78, 14
    s_cbranch_scc1 L_t23
    s_bitcmp1_b32 s78, 6
    s_cbranch_scc1 L_u23
    s_waitcnt vmcnt(3)
L_u23:
    s_waitcnt vmcnt(4)
L_t23:
    s_xor_b32 s57, s48, 18432
    buffer_load_dwordx4 v[72:75], v1, s[32:35], s57 offen nt
    s_bitcmp1_b32 s78, 31
    s_cbranch_scc1 L_t24
    s_waitcnt vmcnt(9)
    s_bitcmp1_b32 s78, 23
    s_cbranch_scc1 L_t24
    s_waitcnt vmcnt(6)
    s_bitcmp1_b32 s78, 15
    s_cbranch_scc1 L_t24
    s_bitcmp1_b32 s78, 7
    s_cbranch_scc1 L_u24
    s_waitcnt vmcnt(3)
L_u24:
    s_waitcnt vmcnt(4)
L_t24:
    s_xor_b32 s57, s48, 27648
    buffer_load_dwordx4 v[76:79], v1, s[32:35], s57 offen nt
    v_add_f32_dpp v24, v32, v24 row_ror:8 row_mask:0xf bank_mask:0xf
    v_add_f32_dpp v25, v33, v25 row_ror:8 row_mask:0xf bank_mask:0xf
    v_add_f32_dpp v26, v34, v26 row_ror:8 row_mask:0xf bank_mask:0xf
    v_add_f32_dpp v27, v35, v27 row_ror:8 row_mask:0xf bank_mask:0xf
    v_add_f32_dpp v24, v24, v24 row_half_mirror row_mask:0xf bank_mask:0x5
    v_add_f32_dpp v24, v25, v25 row_half_mirror row_mask:0xf bank_mask:0xa
    v_add_f32_dpp v26, v26, v26 row_half_mirror row_mask:0xf bank_mask:0x5
    v_add_f32_dpp v26, v27, v27 row_half_mirror row_mask:0xf bank_mask:0xa
    v_add_f32_dpp v24, v24, v24 quad_perm:[1,0,3,2] row_mask:0xf bank_mask:0xf
    s_nop 0
    v_add_f32_dpp v26, v26, v26 quad_perm:[1,0,3,2] row_mask:0xf bank_mask:0xf
    v_add_f32_dpp v24, v24, v24 quad_perm:[2,3,0,1] row_mask:0xf bank_mask:0xf
    s_nop 0
    v_add_f32_dpp v26, v26, v26 quad_perm:[2,3,0,1] row_mask:0xf bank_mask:0xf
    ds_write_b32 v45, v24 offset:9856
    v_max3_f32 v44, v44, v24, v26
    ds_write_b32 v45, v26 offset:9920
    s_barrier
    ds_read_b32 v0, v17 offset:8704
    s_waitcnt lgkmcnt(0)
    v_readfirstlane_b32 s78, v0
    s_waitcnt vmcnt(12)
    v_dot2_f32_bf16 v20, v112, v4, 0
    v_dot2_f32_bf16 v21, v116, v4, 0
    v_dot2_f32_bf16 v22, v120, v4, 0
    v_dot2_f32_bf16 v23, v124, v4, 0
    v_dot2_f32_bf16 v20, v113, v5, v20
    v_dot2_f32_bf16 v21, v117, v5, v21
    v_dot2_f32_bf16 v22, v121, v5, v22
    v_dot2_f32_bf16 v23, v125, v5, v23
    v_dot2_f32_bf16 v20, v114, v6, v20
    v_dot2_f32_bf16 v21, v118, v6, v21
    v_dot2_f32_bf16 v22, v122, v6, v22
    v_dot2_f32_bf16 v23, v126, v6, v23
    v_dot2_f32_bf16 v20, v115, v7, v20
    v_dot2_f32_bf16 v21, v119, v7, v21
    v_dot2_f32_bf16 v22, v123, v7, v22
    v_dot2_f32_bf16 v23, v127, v7, v23
    s_bitcmp1_b32 s78, 24
    s_cbranch_scc1 L_t25
    s_waitcnt vmcnt(9)
    s_bitcmp1_b32 s78, 16
    s_cbranch_scc1 L_t25
    s_waitcnt vmcnt(6)
    s_bitcmp1_b32 s78, 8
    s_cbranch_scc1 L_t25
    s_bitcmp1_b32 s78, 0
    s_cbranch_scc1 L_u25
    s_waitcnt vmcnt(3)
L_u25:
    s_waitcnt vmcnt(4)
L_t25:
    buffer_load_dwordx4 v[80:83], v246, s[32:35], s48 offen nt
    s_bitcmp1_b32 s78, 25
    s_cbranch_scc1 L_t26
    s_waitcnt vmcnt(9)
    s_bitcmp1_b32 s78, 17
    s_cbranch_scc1 L_t26
    s_waitcnt vmcnt(6)
    s_bitcmp1_b32 s78, 9
    s_cbranch_scc1 L_t26
    s_bitcmp1_b32 s78, 1
    s_cbranch_scc1 L_u26
    s_waitcnt vmcnt(3)
L_u26:
    s_waitcnt vmcnt(4)
L_t26:
    s_xor_b32 s57, s48, 9216
    buffer_load_dwordx4 v[84:87], v246, s[32:35], s57 offen nt
    s_waitcnt vmcnt(12)
    v_dot2_f32_bf16 v24, v128, v4, 0
    v_dot2_f32_bf16 v25, v132, v4, 0
    v_dot2_f32_bf16 v26, v136, v4, 0
    v_dot2_f32_bf16 v27, v140, v4, 0
    v_dot2_f32_bf16 v24, v129, v5, v24
    v_dot2_f32_bf16 v25, v133, v5, v25
    v_dot2_f32_bf16 v26, v137, v5, v26
    v_dot2_f32_bf16 v27, v141, v5, v27
    v_dot2_f32_bf16 v24, v130, v6, v24
    v_dot2_f32_bf16 v25, v134, v6, v25
    v_dot2_f32_bf16 v26, v138, v6, v26
    v_dot2_f32_bf16 v27, v142, v6, v27
    v_dot2_f32_bf16 v24, v131, v7, v24
    v_dot2_f32_bf16 v25, v135, v7, v25
    v_dot2_f32_bf16 v26, v139, v7, v26
    v_dot2_f32_bf16 v27, v143, v7, v27
    s_bitcmp1_b32 s78, 26
    s_cbranch_scc1 L_t27
    s_waitcnt vmcnt(9)
    s_bitcmp1_b32 s78, 18
    s_cbranch_scc1 L_t27
    s_waitcnt vmcnt(6)
    s_bitcmp1_b32 s78, 10
    s_cbranch_scc1 L_t27
    s_bitcmp1_b32 s78, 2
    s_cbranch_scc1 L_u27
    s_waitcnt vmcnt(3)
L_u27:
    s_waitcnt vmcnt(4)
L_t27:
    s_xor_b32 s57, s48, 2048
    buffer_load_dwordx4 v[88:91], v246, s[32:35], s57 offen nt
    s_bitcmp1_b32 s78, 27
    s_cbranch_scc1 L_t28
    s_waitcnt vmcnt(9)
    s_bitcmp1_b32 s78, 19
    s_cbranch_scc1 L_t28
    s_waitcnt vmcnt(6)
    s_bitcmp1_b32 s78, 11
    s_cbranch_scc1 L_t28
    s_bitcmp1_b32 s78, 3
    s_cbranch_scc1 L_u28
    s_waitcnt vmcnt(3)
L_u28:
    s_waitcnt vmcnt(4)
L_t28:
    s_xor_b32 s57, s48, 11264
    buffer_load_dwordx4 v[92:95], v246, s[32:35], s57 offen nt
    s_waitcnt vmcnt(12)
    v_dot2_f32_bf16 v28, v144, v4, 0
    v_dot2_f32_bf16 v29, v148, v4, 0
    v_dot2_f32_bf16 v30, v152, v4, 0
    v_dot2_f32_bf16 v31, v156, v4, 0
    v_dot2_f32_bf16 v28, v145, v5, v28
    v_dot2_f32_bf16 v29, v149, v5, v29
    v_dot2_f32_bf16 v30, v153, v5, v30
    v_dot2_f32_bf16 v31, v157, v5, v31
    v_dot2_f32_bf16 v28, v146, v6, v28
    v_dot2_f32_bf16 v29, v150, v6, v29
    v_dot2_f32_bf16 v30, v154, v6, v30
    v_dot2_f32_bf16 v31, v158, v6, v31
    v_dot2_f32_bf16 v28, v147, v7, v28
    v_dot2_f32_bf16 v29, v151, v7, v29
    v_dot2_f32_bf16 v30, v155, v7, v30
    v_dot2_f32_bf16 v31, v159, v7, v31
    s_bitcmp1_b32 s78, 28
    s_cbranch_scc1 L_t29
    s_waitcnt vmcnt(9)
    s_bitcmp1_b32 s78, 20
    s_cbranch_scc1 L_t29
    s_waitcnt vmcnt(6)
    s_bitcmp1_b32 s78, 12
    s_cbranch_scc1 L_t29
    s_bitcmp1_b32 s78, 4
    s_cbranch_scc1 L_u29
    s_waitcnt vmcnt(3)
L_u29:
    s_waitcnt vmcnt(4)
L_t29:
    s_xor_b32 s57, s48, 16384
    buffer_load_dwordx4 v[96:99], v246, s[32:35], s57 offen nt
    s_bitcmp1_b32 s78, 29
    s_cbranch_scc1 L_t30
    s_waitcnt vmcnt(9)
    s_bitcmp1_b32 s78, 21
    s_cbranch_scc1 L_t30
    s_waitcnt vmcnt(6)
    s_bitcmp1_b32 s78, 13
    s_cbranch_scc1 L_t30
    s_bitcmp1_b32 s78, 5
    s_cbranch_scc1 L_u30
    s_waitcnt vmcnt(3)
L_u30:
    s_waitcnt vmcnt(4)
L_t30:
    s_xor_b32 s57, s48, 25600
    buffer_load_dwordx4 v[100:103], v246, s[32:35], s57 offen nt
    v_add_f32_dpp v20, v28, v20 row_ror:8 row_mask:0xf bank_mask:0xf
    v_add_f32_dpp v21, v29, v21 row_ror:8 row_mask:0xf bank_mask:0xf
    v_add_f32_dpp v22, v30, v22 row_ror:8 row_mask:0xf bank_mask:0xf
    v_add_f32_dpp v23, v31, v23 row_ror:8 row_mask:0xf bank_mask:0xf
    v_add_f32_dpp v20, v20, v20 row_half_mirror row_mask:0xf bank_mask:0x5
    v_add_f32_dpp v20, v21, v21 row_half_mirror row_mask:0xf bank_mask:0xa
    v_add_f32_dpp v22, v22, v22 row_half_mirror row_mask:0xf bank_mask:0x5
    v_add_f32_dpp v22, v23, v23 row_half_mirror row_mask:0xf bank_mask:0xa
    v_add_f32_dpp v20, v20, v20 quad_perm:[1,0,3,2] row_mask:0xf bank_mask:0xf
    s_nop 0
    v_add_f32_dpp v22, v22, v22 quad_perm:[1,0,3,2] row_mask:0xf bank_mask:0xf
    v_add_f32_dpp v20, v20, v20 quad_perm:[2,3,0,1] row_mask:0xf bank_mask:0xf
    s_nop 0
    v_add_f32_dpp v22, v22, v22 quad_perm:[2,3,0,1] row_mask:0xf bank_mask:0xf
    ds_write_b32 v45, v20 offset:9984
    v_max3_f32 v44, v44, v20, v22
    ds_write_b32 v45, v22 offset:10048
    s_waitcnt vmcnt(12)
    v_dot2_f32_bf16 v32, v160, v4, 0
    v_dot2_f32_bf16 v33, v164, v4, 0
    v_dot2_f32_bf16 v34, v168, v4, 0
    v_dot2_f32_bf16 v35, v172, v4, 0
    v_dot2_f32_bf16 v32, v161, v5, v32
    v_dot2_f32_bf16 v33, v165, v5, v33
    v_dot2_f32_bf16 v34, v169, v5, v34
    v_dot2_f32_bf16 v35, v173, v5, v35
    v_dot2_f32_bf16 v32, v162, v6, v32
    v_dot2_f32_bf16 v33, v166, v6, v33
    v_dot2_f32_bf16 v34, v170, v6, v34
    v_dot2_f32_bf16 v35, v174, v6, v35
    v_dot2_f32_bf16 v32, v163, v7, v32
    v_dot2_f32_bf16 v33, v167, v7, v33
    v_dot2_f32_bf16 v34, v171, v7, v34
    v_dot2_f32_bf16 v35, v175, v7, v35
    s_bitcmp1_b32 s78, 30
    s_cbranch_scc1 L_t31
    s_waitcnt vmcnt(9)
    s_bitcmp1_b32 s78, 22
    s_cbranch_scc1 L_t31
    s_waitcnt vmcnt(6)
    s_bitcmp1_b32 s78, 14
    s_cbranch_scc1 L_t31
    s_bitcmp1_b32 s78, 6
    s_cbranch_scc1 L_u31
    s_waitcnt vmcnt(3)
L_u31:
    s_waitcnt vmcnt(4)
L_t31:
    s_xor_b32 s57, s48, 18432
    buffer_load_dwordx4 v[104:107], v246, s[32:35], s57 offen nt
    s_bitcmp1_b32 s78, 31
    s_cbranch_scc1 L_t32
    s_waitcnt vmcnt(9)
    s_bitcmp1_b32 s78, 23
    s_cbranch_scc1 L_t32
    s_waitcnt vmcnt(6)
    s_bitcmp1_b32 s78, 15
    s_cbranch_scc1 L_t32
    s_bitcmp1_b32 s78, 7
    s_cbranch_scc1 L_u32
    s_waitcnt vmcnt(3)
L_u32:
    s_waitcnt vmcnt(4)
L_t32:
    s_xor_b32 s57, s48, 27648
    buffer_load_dwordx4 v[108:111], v246, s[32:35], s57 offen nt
    s_add_u32 s48, s48, 0x10000
    v_add_f32_dpp v24, v32, v24 row_ror:8 row_mask:0xf bank_mask:0xf
    v_add_f32_dpp v25, v33, v25 row_ror:8 row_mask:0xf bank_mask:0xf
    v_add_f32_dpp v26, v34, v26 row_ror:8 row_mask:0xf bank_mask:0xf
    v_add_f32_dpp v27, v35, v27 row_ror:8 row_mask:0xf bank_mask:0xf
    v_add_f32_dpp v24, v24, v24 row_half_mirror row_mask:0xf bank_mask:0x5
    v_add_f32_dpp v24, v25, v25 row_half_mirror row_mask:0xf bank_mask:0xa
    v_add_f32_dpp v26, v26, v26 row_half_mirror row_mask:0xf bank_mask:0x5
    v_add_f32_dpp v26, v27, v27 row_half_mirror row_mask:0xf bank_mask:0xa
    v_add_f32_dpp v24, v24, v24 quad_perm:[1,0,3,2] row_mask:0xf bank_mask:0xf
    s_nop 0
    v_add_f32_dpp v26, v26, v26 quad_perm:[1,0,3,2] row_mask:0xf bank_mask:0xf
    v_add_f32_dpp v24, v24, v24 quad_perm:[2,3,0,1] row_mask:0xf bank_mask:0xf
    s_nop 0
    v_add_f32_dpp v26, v26, v26 quad_perm:[2,3,0,1] row_mask:0xf bank_mask:0xf
    ds_write_b32 v45, v24 offset:10112
    v_max3_f32 v44, v44, v24, v26
    ds_write_b32 v45, v26 offset:10176
    s_mov_b32 s51, 4
    s_mov_b32 s59, 8
    s_mov_b32 s53, 0
    s_mov_b32 s60, s6
    s_mov_b32 s61, s7
    s_mov_b32 s62, s49
L_k2v:
    s_lshl_b32 s56, s3, 2
    v_mov_b32 v19, s56
    v_max_f32_dpp v44, v44, v44 row_ror:4 row_mask:0xf bank_mask:0xf
    s_nop 1
    v_max_f32_dpp v44, v44, v44 row_ror:8 row_mask:0xf bank_mask:0xf
    v_mov_b32 v20, v44
    s_nop 1
    v_permlane16_swap_b32 v44, v20
    s_nop 1
    v_max_f32 v44, v44, v20
    v_mov_b32 v20, v44
    s_nop 1
    v_permlane32_swap_b32 v44, v20
    s_nop 1
    v_max_f32 v44, v44, v20
    ds_write_b32 v19, v44 offset:2064
    v_and_b32 v45, 60, v18
    v_add_u32 v45, s80, v45
    v_mov_b32 v2, 0
    v_mov_b32 v12, 0
    v_mov_b32 v13, 0
    v_mov_b32 v14, 0
    v_mov_b32 v15, 0
    s_add_u32 s51, s51, 1
    s_waitcnt lgkmcnt(0)
    s_barrier
    ds_read_b128 v[20:23], v17 offset:2064
    s_waitcnt lgkmcnt(0)
    v_max3_f32 v3, v20, v21, v22
    v_max_f32 v3, v3, v23
    v_mul_f32 v16, s54, v3
    v_sub_f32 v16, 0, v16
    s_branch L_vnobar
.p2align 6
L_vloop:
    s_sub_u32 s56, s51, 27
    s_cmp_lt_u32 s56, 8
    s_cbranch_scc1 L_wpiece
L_vret:
    s_add_u32 s51, s51, 1
    s_cmp_eq_u32 s51, s59
    s_cselect_b32 s32, s60, s32
    s_cselect_b32 s33, s61, s33
    s_cselect_b32 s48, s62, s48
    s_barrier
L_vnobar:
    ds_read_b32 v0, v17 offset:8704
    ds_read_b32 v24, v45 offset:9216
    ds_read_b32 v25, v45 offset:9280
    ds_read_b32 v26, v45 offset:9344
    ds_read_b32 v27, v45 offset:9408
    s_waitcnt lgkmcnt(0)
    v_readfirstlane_b32 s78, v0
    v_fma_f32 v24, v24, s54, v16
    v_exp_f32 v24, v24
    v_fma_f32 v25, v25, s54, v16
    v_exp_f32 v25, v25
    v_fma_f32 v26, v26, s54, v16
    v_exp_f32 v26, v26
    v_fma_f32 v27, v27, s54, v16
    v_exp_f32 v27, v27
    v_add_f32 v2, v2, v24
    v_add_f32 v2, v2, v25
    v_add_f32 v2, v2, v26
    v_add_f32 v2, v2, v27
    v_cvt_pk_bf16_f32 v24, v24, v24
    v_cvt_pk_bf16_f32 v25, v25, v25
    v_cvt_pk_bf16_f32 v26, v26, v26
    v_cvt_pk_bf16_f32 v27, v27, v27
    v_and_b32 v28, v24, v8
    v_and_b32 v29, v24, v9
    v_and_b32_dpp v30, v24, v10 row_half_mirror row_mask:0xf bank_mask:0xf
    v_and_b32_dpp v31, v24, v11 row_half_mirror row_mask:0xf bank_mask:0xf
    v_and_b32_dpp v32, v24, v8 row_half_mirror row_mask:0xf bank_mask:0xf
    v_and_b32_dpp v33, v24, v9 row_half_mirror row_mask:0xf bank_mask:0xf
    v_and_b32 v34, v24, v10
    v_and_b32 v35, v24, v11
    v_and_b32 v36, v25, v8
    v_and_b32 v37, v25, v9
    v_and_b32_dpp v38, v25, v10 row_half_mirror row_mask:0xf bank_mask:0xf
    v_and_b32_dpp v39, v25, v11 row_half_mirror row_mask:0xf bank_mask:0xf
    v_and_b32_dpp v40, v25, v8 row_half_mirror row_mask:0xf bank_mask:0xf
    v_and_b32_dpp v41, v25, v9 row_half_mirror row_mask:0xf bank_mask:0xf
    v_and_b32 v42, v25, v10
    v_and_b32 v43, v25, v11
    s_waitcnt vmcnt(12)
    v_mfma_f32_16x16x32_bf16 v[12:15], v[28:31], v[48:51], v[12:15]
    v_mfma_f32_16x16x32_bf16 v[12:15], v[32:35], v[52:55], v[12:15]
    v_mfma_f32_16x16x32_bf16 v[12:15], v[36:39], v[56:59], v[12:15]
    v_mfma_f32_16x16x32_bf16 v[12:15], v[40:43], v[60:63], v[12:15]
    s_bitcmp1_b32 s78, 24
    s_cbranch_scc1 L_t33
    s_waitcnt vmcnt(9)
    s_bitcmp1_b32 s78, 16
    s_cbranch_scc1 L_t33
    s_waitcnt vmcnt(6)
    s_bitcmp1_b32 s78, 8
    s_cbranch_scc1 L_t33
    s_bitcmp1_b32 s78, 0
    s_cbranch_scc1 L_u33
    s_waitcnt vmcnt(3)
L_u33:
    s_waitcnt vmcnt(4)
L_t33:
    buffer_load_dwordx4 v[48:51], v1, s[32:35], s48 offen nt
    s_xor_b32 s57, s48, 9216
    s_bitcmp1_b32 s78, 25
    s_cbranch_scc1 L_t34
    s_waitcnt vmcnt(9)
    s_bitcmp1_b32 s78, 17
    s_cbranch_scc1 L_t34
    s_waitcnt vmcnt(6)
    s_bitcmp1_b32 s78, 9
    s_cbranch_scc1 L_t34
    s_bitcmp1_b32 s78, 1
    s_cbranch_scc1 L_u34
    s_waitcnt vmcnt(3)
L_u34:
    s_waitcnt vmcnt(4)
L_t34:
    buffer_load_dwordx4 v[52:55], v1, s[32:35], s57 offen nt
    s_xor_b32 s57, s48, 2048
    s_bitcmp1_b32 s78, 26
    s_cbranch_scc1 L_t35
    s_waitcnt vmcnt(9)
    s_bitcmp1_b32 s78, 18
    s_cbranch_scc1 L_t35
    s_waitcnt vmcnt(6)
    s_bitcmp1_b32 s78, 10
    s_cbranch_scc1 L_t35
    s_bitcmp1_b32 s78, 2
    s_cbranch_scc1 L_u35
    s_waitcnt vmcnt(3)
L_u35:
    s_waitcnt vmcnt(4)
L_t35:
    buffer_load_dwordx4 v[56:59], v1, s[32:35], s57 offen nt
    s_xor_b32 s57, s48, 11264
    s_bitcmp1_b32 s78, 27
    s_cbranch_scc1 L_t36
    s_waitcnt vmcnt(9)
    s_bitcmp1_b32 s78, 19
    s_cbranch_scc1 L_t36
    s_waitcnt vmcnt(6)
    s_bitcmp1_b32 s78, 11
    s_cbranch_scc1 L_t36
    s_bitcmp1_b32 s78, 3
    s_cbranch_scc1 L_u36
    s_waitcnt vmcnt(3)
L_u36:
    s_waitcnt vmcnt(4)
L_t36:
    buffer_load_dwordx4 v[60:63], v1, s[32:35], s57 offen nt
    v_and_b32 v28, v26, v8
    v_and_b32 v29, v26, v9
    v_and_b32_dpp v30, v26, v10 row_half_mirror row_mask:0xf bank_mask:0xf
    v_and_b32_dpp v31, v26, v11 row_half_mirror row_mask:0xf bank_mask:0xf
    v_and_b32_dpp v32, v26, v8 row_half_mirror row_mask:0xf bank_mask:0xf
    v_and_b32_dpp v33, v26, v9 row_half_mirror row_mask:0xf bank_mask:0xf
    v_and_b32 v34, v26, v10
    v_and_b32 v35, v26, v11
    v_and_b32 v36, v27, v8
    v_and_b32 v37, v27, v9
    v_and_b32_dpp v38, v27, v10 row_half_mirror row_mask:0xf bank_mask:0xf
    v_and_b32_dpp v39, v27, v11 row_half_mirror row_mask:0xf bank_mask:0xf
    v_and_b32_dpp v40, v27, v8 row_half_mirror row_mask:0xf bank_mask:0xf
    v_and_b32_dpp v41, v27, v9 row_half_mirror row_mask:0xf bank_mask:0xf
    v_and_b32 v42, v27, v10
    v_and_b32 v43, v27, v11
    s_waitcnt vmcnt(12)
    v_mfma_f32_16x16x32_bf16 v[12:15], v[28:31], v[64:67], v[12:15]
    v_mfma_f32_16x16x32_bf16 v[12:15], v[32:35], v[68:71], v[12:15]
    v_mfma_f32_16x16x32_bf16 v[12:15], v[36:39], v[72:75], v[12:15]
    v_mfma_f32_16x16x32_bf16 v[12:15], v[40:43], v[76:79], v[12:15]
    s_xor_b32 s57, s48, 16384
    s_bitcmp1_b32 s78, 28
    s_cbranch_scc1 L_t37
    s_waitcnt vmcnt(9)
    s_bitcmp1_b32 s78, 20
    s_cbranch_scc1 L_t37
    s_waitcnt vmcnt(6)
    s_bitcmp1_b32 s78, 12
    s_cbranch_scc1 L_t37
    s_bitcmp1_b32 s78, 4
    s_cbranch_scc1 L_u37
    s_waitcnt vmcnt(3)
L_u37:
    s_waitcnt vmcnt(4)
L_t37:
    buffer_load_dwordx4 v[64:67], v1, s[32:35], s57 offen nt
    s_xor_b32 s57, s48, 25600
    s_bitcmp1_b32 s78, 29
    s_cbranch_scc1 L_t38
    s_waitcnt vmcnt(9)
    s_bitcmp1_b32 s78, 21
    s_cbranch_scc1 L_t38
    s_waitcnt vmcnt(6)
    s_bitcmp1_b32 s78, 13
    s_cbranch_scc1 L_t38
    s_bitcmp1_b32 s78, 5
    s_cbranch_scc1 L_u38
    s_waitcnt vmcnt(3)
L_u38:
    s_waitcnt vmcnt(4)
L_t38:
    buffer_load_dwordx4 v[68:71], v1, s[32:35], s57 offen nt
    s_xor_b32 s57, s48, 18432
    s_bitcmp1_b32 s78, 30
    s_cbranch_scc1 L_t39
    s_waitcnt vmcnt(9)
    s_bitcmp1_b32 s78, 22
    s_cbranch_scc1 L_t39
    s_waitcnt vmcnt(6)
    s_bitcmp1_b32 s78, 14
    s_cbranch_scc1 L_t39
    s_bitcmp1_b32 s78, 6
    s_cbranch_scc1 L_u39
    s_waitcnt vmcnt(3)
L_u39:
    s_waitcnt vmcnt(4)
L_t39:
    buffer_load_dwordx4 v[72:75], v1, s[32:35], s57 offen nt
    s_xor_b32 s57, s48, 27648
    s_bitcmp1_b32 s78, 31
    s_cbranch_scc1 L_t40
    s_waitcnt vmcnt(9)
    s_bitcmp1_b32 s78, 23
    s_cbranch_scc1 L_t40
    s_waitcnt vmcnt(6)
    s_bitcmp1_b32 s78, 15
    s_cbranch_scc1 L_t40
    s_bitcmp1_b32 s78, 7
    s_cbranch_scc1 L_u40
    s_waitcnt vmcnt(3)
L_u40:
    s_waitcnt vmcnt(4)
L_t40:
    buffer_load_dwordx4 v[76:79], v1, s[32:35], s57 offen nt
    s_cmp_eq_u32 s51, 39
    s_cbranch_scc1 L_peel
    s_barrier
    ds_read_b32 v0, v17 offset:8704
    v_mov_b32_dpp v24, v24 row_ror:8 row_mask:0xf bank_mask:0xf
    v_mov_b32_dpp v25, v25 row_ror:8 row_mask:0xf bank_mask:0xf
    v_mov_b32_dpp v26, v26 row_ror:8 row_mask:0xf bank_mask:0xf
    v_mov_b32_dpp v27, v27 row_ror:8 row_mask:0xf bank_mask:0xf
    s_waitcnt lgkmcnt(0)
    v_readfirstlane_b32 s78, v0
    v_and_b32 v28, v24, v8
    v_and_b32 v29, v24, v9
    v_and_b32_dpp v30, v24, v10 row_half_mirror row_mask:0xf bank_mask:0xf
    v_and_b32_dpp v31, v24, v11 row_half_mirror row_mask:0xf bank_mask:0xf
    v_and_b32_dpp v32, v24, v8 row_half_mirror row_mask:0xf bank_mask:0xf
    v_and_b32_dpp v33, v24, v9 row_half_mirror row_mask:0xf bank_mask:0xf
    v_and_b32 v34, v24, v10
    v_and_b32 v35, v24, v11
    v_and_b32 v36, v25, v8
    v_and_b32 v37, v25, v9
    v_and_b32_dpp v38, v25, v10 row_half_mirror row_mask:0xf bank_mask:0xf
    v_and_b32_dpp v39, v25, v11 row_half_mirror row_mask:0xf bank_mask:0xf
    v_and_b32_dpp v40, v25, v8 row_half_mirror row_mask:0xf bank_mask:0xf
    v_and_b32_dpp v41, v25, v9 row_half_mirror row_mask:0xf bank_mask:0xf
    v_and_b32 v42, v25, v10
    v_and_b32 v43, v25, v11
    s_waitcnt vmcnt(12)
    v_mfma_f32_16x16x32_bf16 v[12:15], v[28:31], v[80:83], v[12:15]
    v_mfma_f32_16x16x32_bf16 v[12:15], v[32:35], v[84:87], v[12:15]
    v_mfma_f32_16x16x32_bf16 v[12:15], v[36:39], v[88:91], v[12:15]
    v_mfma_f32_16x16x32_bf16 v[12:15], v[40:43], v[92:95], v[12:15]
    s_bitcmp1_b32 s78, 24
    s_cbranch_scc1 L_t41
    s_waitcnt vmcnt(9)
    s_bitcmp1_b32 s78, 16
    s_cbranch_scc1 L_t41
    s_waitcnt vmcnt(6)
    s_bitcmp1_b32 s78, 8
    s_cbranch_scc1 L_t41
    s_bitcmp1_b32 s78, 0
    s_cbranch_scc1 L_u41
    s_waitcnt vmcnt(3)
L_u41:
    s_waitcnt vmcnt(4)
L_t41:
    buffer_load_dwordx4 v[80:83], v246, s[32:35], s48 offen nt
    s_xor_b32 s57, s48, 9216
    s_bitcmp1_b32 s78, 25
    s_cbranch_scc1 L_t42
    s_waitcnt vmcnt(9)
    s_bitcmp1_b32 s78, 17
    s_cbranch_scc1 L_t42
    s_waitcnt vmcnt(6)
    s_bitcmp1_b32 s78, 9
    s_cbranch_scc1 L_t42
    s_bitcmp1_b32 s78, 1
    s_cbranch_scc1 L_u42
    s_waitcnt vmcnt(3)
L_u42:
    s_waitcnt vmcnt(4)
L_t42:
    buffer_load_dwordx4 v[84:87], v246, s[32:35], s57 offen nt
    s_xor_b32 s57, s48, 2048
    s_bitcmp1_b32 s78, 26
    s_cbranch_scc1 L_t43
    s_waitcnt vmcnt(9)
    s_bitcmp1_b32 s78, 18
    s_cbranch_scc1 L_t43
    s_waitcnt vmcnt(6)
    s_bitcmp1_b32 s78, 10
    s_cbranch_scc1 L_t43
    s_bitcmp1_b32 s78, 2
    s_cbranch_scc1 L_u43
    s_waitcnt vmcnt(3)
L_u43:
    s_waitcnt vmcnt(4)
L_t43:
    buffer_load_dwordx4 v[88:91], v246, s[32:35], s57 offen nt
    s_xor_b32 s57, s48, 11264
    s_bitcmp1_b32 s78, 27
    s_cbranch_scc1 L_t44
    s_waitcnt vmcnt(9)
    s_bitcmp1_b32 s78, 19
    s_cbranch_scc1 L_t44
    s_waitcnt vmcnt(6)
    s_bitcmp1_b32 s78, 11
    s_cbranch_scc1 L_t44
    s_bitcmp1_b32 s78, 3
    s_cbranch_scc1 L_u44
    s_waitcnt vmcnt(3)
L_u44:
    s_waitcnt vmcnt(4)
L_t44:
    buffer_load_dwordx4 v[92:95], v246, s[32:35], s57 offen nt
    v_and_b32 v28, v26, v8
    v_and_b32 v29, v26, v9
    v_and_b32_dpp v30, v26, v10 row_half_mirror row_mask:0xf bank_mask:0xf
    v_and_b32_dpp v31, v26, v11 row_half_mirror row_mask:0xf bank_mask:0xf
    v_and_b32_dpp v32, v26, v8 row_half_mirror row_mask:0xf bank_mask:0xf
    v_and_b32_dpp v33, v26, v9 row_half_mirror row_mask:0xf bank_mask:0xf
    v_and_b32 v34, v26, v10
    v_and_b32 v35, v26, v11
    v_and_b32 v36, v27, v8
    v_and_b32 v37, v27, v9
    v_and_b32_dpp v38, v27, v10 row_half_mirror row_mask:0xf bank_mask:0xf
    v_and_b32_dpp v39, v27, v11 row_half_mirror row_mask:0xf bank_mask:0xf
    v_and_b32_dpp v40, v27, v8 row_half_mirror row_mask:0xf bank_mask:0xf
    v_and_b32_dpp v41, v27, v9 row_half_mirror row_mask:0xf bank_mask:0xf
    v_and_b32 v42, v27, v10
    v_and_b32 v43, v27, v11
    s_waitcnt vmcnt(12)
    v_mfma_f32_16x16x32_bf16 v[12:15], v[28:31], v[96:99], v[12:15]
    v_mfma_f32_16x16x32_bf16 v[12:15], v[32:35], v[100:103], v[12:15]
    v_mfma_f32_16x16x32_bf16 v[12:15], v[36:39], v[104:107], v[12:15]
    v_mfma_f32_16x16x32_bf16 v[12:15], v[40:43], v[108:111], v[12:15]
    s_xor_b32 s57, s48, 16384
    s_bitcmp1_b32 s78, 28
    s_cbranch_scc1 L_t45
    s_waitcnt vmcnt(9)
    s_bitcmp1_b32 s78, 20
    s_cbranch_scc1 L_t45
    s_waitcnt vmcnt(6)
    s_bitcmp1_b32 s78, 12
    s_cbranch_scc1 L_t45
    s_bitcmp1_b32 s78, 4
    s_cbranch_scc1 L_u45
    s_waitcnt vmcnt(3)
L_u45:
    s_waitcnt vmcnt(4)
L_t45:
    buffer_load_dwordx4 v[96:99], v246, s[32:35], s57 offen nt
    s_xor_b32 s57, s48, 25600
    s_bitcmp1_b32 s78, 29
    s_cbranch_scc1 L_t46
    s_waitcnt vmcnt(9)
    s_bitcmp1_b32 s78, 21
    s_cbranch_scc1 L_t46
    s_waitcnt vmcnt(6)
    s_bitcmp1_b32 s78, 13
    s_cbranch_scc1 L_t46
    s_bitcmp1_b32 s78, 5
    s_cbranch_scc1 L_u46
    s_waitcnt vmcnt(3)
L_u46:
    s_waitcnt vmcnt(4)
L_t46:
    buffer_load_dwordx4 v[100:103], v246, s[32:35], s57 offen nt
    s_xor_b32 s57, s48, 18432
    s_bitcmp1_b32 s78, 30
    s_cbranch_scc1 L_t47
    s_waitcnt vmcnt(9)
    s_bitcmp1_b32 s78, 22
    s_cbranch_scc1 L_t47
    s_waitcnt vmcnt(6)
    s_bitcmp1_b32 s78, 14
    s_cbranch_scc1 L_t47
    s_bitcmp1_b32 s78, 6
    s_cbranch_scc1 L_u47
    s_waitcnt vmcnt(3)
L_u47:
    s_waitcnt vmcnt(4)
L_t47:
    buffer_load_dwordx4 v[104:107], v246, s[32:35], s57 offen nt
    s_xor_b32 s57, s48, 27648
    s_bitcmp1_b32 s78, 31
    s_cbranch_scc1 L_t48
    s_waitcnt vmcnt(9)
    s_bitcmp1_b32 s78, 23
    s_cbranch_scc1 L_t48
    s_waitcnt vmcnt(6)
    s_bitcmp1_b32 s78, 15
    s_cbranch_scc1 L_t48
    s_bitcmp1_b32 s78, 7
    s_cbranch_scc1 L_u48
    s_waitcnt vmcnt(3)
L_u48:
    s_waitcnt vmcnt(4)
L_t48:
    buffer_load_dwordx4 v[108:111], v246, s[32:35], s57 offen nt
    s_add_u32 s48, s48, 0x10000
    v_add_u32 v45, 256, v45
    s_cmp_lt_u32 s51, s59
    s_cbranch_scc1 L_vloop
    s_branch L_v2k
L_peel:
    s_barrier
    ds_read_b32 v0, v17 offset:8704
    v_mov_b32_dpp v24, v24 row_ror:8 row_mask:0xf bank_mask:0xf
    v_mov_b32_dpp v25, v25 row_ror:8 row_mask:0xf bank_mask:0xf
    v_mov_b32_dpp v26, v26 row_ror:8 row_mask:0xf bank_mask:0xf
    v_mov_b32_dpp v27, v27 row_ror:8 row_mask:0xf bank_mask:0xf
    s_waitcnt lgkmcnt(0)
    v_readfirstlane_b32 s78, v0
    v_and_b32 v28, v24, v8
    v_and_b32 v29, v24, v9
    v_and_b32_dpp v30, v24, v10 row_half_mirror row_mask:0xf bank_mask:0xf
    v_and_b32_dpp v31, v24, v11 row_half_mirror row_mask:0xf bank_mask:0xf
    v_and_b32_dpp v32, v24, v8 row_half_mirror row_mask:0xf bank_mask:0xf
    v_and_b32_dpp v33, v24, v9 row_half_mirror row_mask:0xf bank_mask:0xf
    v_and_b32 v34, v24, v10
    v_and_b32 v35, v24, v11
    v_and_b32 v36, v25, v8
    v_and_b32 v37, v25, v9
    v_and_b32_dpp v38, v25, v10 row_half_mirror row_mask:0xf bank_mask:0xf
    v_and_b32_dpp v39, v25, v11 row_half_mirror row_mask:0xf bank_mask:0xf
    v_and_b32_dpp v40, v25, v8 row_half_mirror row_mask:0xf bank_mask:0xf
    v_and_b32_dpp v41, v25, v9 row_half_mirror row_mask:0xf bank_mask:0xf
    v_and_b32 v42, v25, v10
    v_and_b32 v43, v25, v11
    s_waitcnt vmcnt(12)
    v_mfma_f32_16x16x32_bf16 v[12:15], v[28:31], v[80:83], v[12:15]
    v_mfma_f32_16x16x32_bf16 v[12:15], v[32:35], v[84:87], v[12:15]
    v_mfma_f32_16x16x32_bf16 v[12:15], v[36:39], v[88:91], v[12:15]
    v_mfma_f32_16x16x32_bf16 v[12:15], v[40:43], v[92:95], v[12:15]
    s_waitcnt vmcnt(12)
    buffer_load_dwordx4 v[80:83], v246, s[32:35], s48 offen nt
    s_xor_b32 s57, s48, 9216
    s_waitcnt vmcnt(12)
    buffer_load_dwordx4 v[84:87], v246, s[32:35], s57 offen nt
    s_xor_b32 s57, s48, 2048
    s_waitcnt vmcnt(12)
    buffer_load_dwordx4 v[88:91], v246, s[32:35], s57 offen nt
    s_xor_b32 s57, s48, 11264
    s_waitcnt vmcnt(12)
    buffer_load_dwordx4 v[92:95], v246, s[32:35], s57 offen nt
    v_and_b32 v28, v26, v8
    v_and_b32 v29, v26, v9
    v_and_b32_dpp v30, v26, v10 row_half_mirror row_mask:0xf bank_mask:0xf
    v_and_b32_dpp v31, v26, v11 row_half_mirror row_mask:0xf bank_mask:0xf
    v_and_b32_dpp v32, v26, v8 row_half_mirror row_mask:0xf bank_mask:0xf
    v_and_b32_dpp v33, v26, v9 row_half_mirror row_mask:0xf bank_mask:0xf
    v_and_b32 v34, v26, v10
    v_and_b32 v35, v26, v11
    v_and_b32 v36, v27, v8
    v_and_b32 v37, v27, v9
    v_and_b32_dpp v38, v27, v10 row_half_mirror row_mask:0xf bank_mask:0xf
    v_and_b32_dpp v39, v27, v11 row_half_mirror row_mask:0xf bank_mask:0xf
    v_and_b32_dpp v40, v27, v8 row_half_mirror row_mask:0xf bank_mask:0xf
    v_and_b32_dpp v41, v27, v9 row_half_mirror row_mask:0xf bank_mask:0xf
    v_and_b32 v42, v27, v10
    v_and_b32 v43, v27, v11
    s_waitcnt vmcnt(12)
    v_mfma_f32_16x16x32_bf16 v[12:15], v[28:31], v[96:99], v[12:15]
    v_mfma_f32_16x16x32_bf16 v[12:15], v[32:35], v[100:103], v[12:15]
    v_mfma_f32_16x16x32_bf16 v[12:15], v[36:39], v[104:107], v[12:15]
    v_mfma_f32_16x16x32_bf16 v[12:15], v[40:43], v[108:111], v[12:15]
    s_xor_b32 s57, s48, 16384
    s_waitcnt vmcnt(12)
    buffer_load_dwordx4 v[96:99], v246, s[32:35], s57 offen nt
    s_xor_b32 s57, s48, 25600
    s_waitcnt vmcnt(12)
    buffer_load_dwordx4 v[100:103], v246, s[32:35], s57 offen nt
    s_xor_b32 s57, s48, 18432
    s_waitcnt vmcnt(12)
    buffer_load_dwordx4 v[104:107], v246, s[32:35], s57 offen nt
    s_xor_b32 s57, s48, 27648
    s_waitcnt vmcnt(12)
    buffer_load_dwordx4 v[108:111], v246, s[32:35], s57 offen nt
    s_add_u32 s48, s48, 0x10000
    v_add_u32 v45, 256, v45
L_drain:
    ds_read_b32 v24, v45 offset:9216
    ds_read_b32 v25, v45 offset:9280
    ds_read_b32 v26, v45 offset:9344
    ds_read_b32 v27, v45 offset:9408
    s_lshl_b32 s56, s3, 2
    v_mov_b32 v19, s56
    s_waitcnt lgkmcnt(0)
    v_fma_f32 v24, v24, s54, v16
    v_exp_f32 v24, v24
    v_fma_f32 v25, v25, s54, v16
    v_exp_f32 v25, v25
    v_fma_f32 v26, v26, s54, v16
    v_exp_f32 v26, v26
    v_fma_f32 v27, v27, s54, v16
    v_exp_f32 v27, v27
    v_add_f32 v2, v2, v24
    v_add_f32 v2, v2, v25
    v_add_f32 v2, v2, v26
    v_add_f32 v2, v2, v27
    v_cvt_pk_bf16_f32 v24, v24, v24
    v_cvt_pk_bf16_f32 v25, v25, v25
    v_cvt_pk_bf16_f32 v26, v26, v26
    v_cvt_pk_bf16_f32 v27, v27, v27
    v_add_f32_dpp v2, v2, v2 row_ror:4 row_mask:0xf bank_mask:0xf
    s_nop 1
    v_add_f32_dpp v2, v2, v2 row_ror:8 row_mask:0xf bank_mask:0xf
    v_mov_b32 v20, v2
    s_nop 1
    v_permlane16_swap_b32 v2, v20
    s_nop 1
    v_add_f32 v2, v2, v20
    v_mov_b32 v20, v2
    s_nop 1
    v_permlane32_swap_b32 v2, v20
    s_nop 1
    v_add_f32 v2, v2, v20
    ds_write_b32 v19, v2 offset:2048
    s_waitcnt lgkmcnt(0)
    s_barrier
    v_and_b32 v28, v24, v8
    v_and_b32 v29, v24, v9
    v_and_b32_dpp v30, v24, v10 row_half_mirror row_mask:0xf bank_mask:0xf
    v_and_b32_dpp v31, v24, v11 row_half_mirror row_mask:0xf bank_mask:0xf
    v_and_b32_dpp v32, v24, v8 row_half_mirror row_mask:0xf bank_mask:0xf
    v_and_b32_dpp v33, v24, v9 row_half_mirror row_mask:0xf bank_mask:0xf
    v_and_b32 v34, v24, v10
    v_and_b32 v35, v24, v11
    v_and_b32 v36, v25, v8
    v_and_b32 v37, v25, v9
    v_and_b32_dpp v38, v25, v10 row_half_mirror row_mask:0xf bank_mask:0xf
    v_and_b32_dpp v39, v25, v11 row_half_mirror row_mask:0xf bank_mask:0xf
    v_and_b32_dpp v40, v25, v8 row_half_mirror row_mask:0xf bank_mask:0xf
    v_and_b32_dpp v41, v25, v9 row_half_mirror row_mask:0xf bank_mask:0xf
    v_and_b32 v42, v25, v10
    v_and_b32 v43, v25, v11
    s_waitcnt vmcnt(15)
    v_mfma_f32_16x16x32_bf16 v[12:15], v[28:31], v[48:51], v[12:15]
    s_waitcnt vmcnt(14)
    v_mfma_f32_16x16x32_bf16 v[12:15], v[32:35], v[52:55], v[12:15]
    s_waitcnt vmcnt(13)
    v_mfma_f32_16x16x32_bf16 v[12:15], v[36:39], v[56:59], v[12:15]
    s_waitcnt vmcnt(12)
    v_mfma_f32_16x16x32_bf16 v[12:15], v[40:43], v[60:63], v[12:15]
    v_and_b32 v28, v26, v8
    v_and_b32 v29, v26, v9
    v_and_b32_dpp v30, v26, v10 row_half_mirror row_mask:0xf bank_mask:0xf
    v_and_b32_dpp v31, v26, v11 row_half_mirror row_mask:0xf bank_mask:0xf
    v_and_b32_dpp v32, v26, v8 row_half_mirror row_mask:0xf bank_mask:0xf
    v_and_b32_dpp v33, v26, v9 row_half_mirror row_mask:0xf bank_mask:0xf
    v_and_b32 v34, v26, v10
    v_and_b32 v35, v26, v11
    v_and_b32 v36, v27, v8
    v_and_b32 v37, v27, v9
    v_and_b32_dpp v38, v27, v10 row_half_mirror row_mask:0xf bank_mask:0xf
    v_and_b32_dpp v39, v27, v11 row_half_mirror row_mask:0xf bank_mask:0xf
    v_and_b32_dpp v40, v27, v8 row_half_mirror row_mask:0xf bank_mask:0xf
    v_and_b32_dpp v41, v27, v9 row_half_mirror row_mask:0xf bank_mask:0xf
    v_and_b32 v42, v27, v10
    v_and_b32 v43, v27, v11
    s_waitcnt vmcnt(11)
    v_mfma_f32_16x16x32_bf16 v[12:15], v[28:31], v[64:67], v[12:15]
    s_waitcnt vmcnt(10)
    v_mfma_f32_16x16x32_bf16 v[12:15], v[32:35], v[68:71], v[12:15]
    s_waitcnt vmcnt(9)
    v_mfma_f32_16x16x32_bf16 v[12:15], v[36:39], v[72:75], v[12:15]
    s_waitcnt vmcnt(8)
    v_mfma_f32_16x16x32_bf16 v[12:15], v[40:43], v[76:79], v[12:15]
    v_mov_b32_dpp v24, v24 row_ror:8 row_mask:0xf bank_mask:0xf
    v_mov_b32_dpp v25, v25 row_ror:8 row_mask:0xf bank_mask:0xf
    v_mov_b32_dpp v26, v26 row_ror:8 row_mask:0xf bank_mask:0xf
    v_mov_b32_dpp v27, v27 row_ror:8 row_mask:0xf bank_mask:0xf
    v_and_b32 v28, v24, v8
    v_and_b32 v29, v24, v9
    v_and_b32_dpp v30, v24, v10 row_half_mirror row_mask:0xf bank_mask:0xf
    v_and_b32_dpp v31, v24, v11 row_half_mirror row_mask:0xf bank_mask:0xf
    v_and_b32_dpp v32, v24, v8 row_half_mirror row_mask:0xf bank_mask:0xf
    v_and_b32_dpp v33, v24, v9 row_half_mirror row_mask:0xf bank_mask:0xf
    v_and_b32 v34, v24, v10
    v_and_b32 v35, v24, v11
    v_and_b32 v36, v25, v8
    v_and_b32 v37, v25, v9
    v_and_b32_dpp v38, v25, v10 row_half_mirror row_mask:0xf bank_mask:0xf
    v_and_b32_dpp v39, v25, v11 row_half_mirror row_mask:0xf bank_mask:0xf
    v_and_b32_dpp v40, v25, v8 row_half_mirror row_mask:0xf bank_mask:0xf
    v_and_b32_dpp v41, v25, v9 row_half_mirror row_mask:0xf bank_mask:0xf
    v_and_b32 v42, v25, v10
    v_and_b32 v43, v25, v11
    s_waitcnt vmcnt(7)
    v_mfma_f32_16x16x32_bf16 v[12:15], v[28:31], v[80:83], v[12:15]
    s_waitcnt vmcnt(6)
    v_mfma_f32_16x16x32_bf16 v[12:15], v[32:35], v[84:87], v[12:15]
    s_waitcnt vmcnt(5)
    v_mfma_f32_16x16x32_bf16 v[12:15], v[36:39], v[88:91], v[12:15]
    s_waitcnt vmcnt(4)
    v_mfma_f32_16x16x32_bf16 v[12:15], v[40:43], v[92:95], v[12:15]
    v_and_b32 v28, v26, v8
    v_and_b32 v29, v26, v9
    v_and_b32_dpp v30, v26, v10 row_half_mirror row_mask:0xf bank_mask:0xf
    v_and_b32_dpp v31, v26, v11 row_half_mirror row_mask:0xf bank_mask:0xf
    v_and_b32_dpp v32, v26, v8 row_half_mirror row_mask:0xf bank_mask:0xf
    v_and_b32_dpp v33, v26, v9 row_half_mirror row_mask:0xf bank_mask:0xf
    v_and_b32 v34, v26, v10
    v_and_b32 v35, v26, v11
    v_and_b32 v36, v27, v8
    v_and_b32 v37, v27, v9
    v_and_b32_dpp v38, v27, v10 row_half_mirror row_mask:0xf bank_mask:0xf
    v_and_b32_dpp v39, v27, v11 row_half_mirror row_mask:0xf bank_mask:0xf
    v_and_b32_dpp v40, v27, v8 row_half_mirror row_mask:0xf bank_mask:0xf
    v_and_b32_dpp v41, v27, v9 row_half_mirror row_mask:0xf bank_mask:0xf
    v_and_b32 v42, v27, v10
    v_and_b32 v43, v27, v11
    s_waitcnt vmcnt(3)
    v_mfma_f32_16x16x32_bf16 v[12:15], v[28:31], v[96:99], v[12:15]
    s_waitcnt vmcnt(2)
    v_mfma_f32_16x16x32_bf16 v[12:15], v[32:35], v[100:103], v[12:15]
    s_waitcnt vmcnt(1)
    v_mfma_f32_16x16x32_bf16 v[12:15], v[36:39], v[104:107], v[12:15]
    s_waitcnt vmcnt(0)
    v_mfma_f32_16x16x32_bf16 v[12:15], v[40:43], v[108:111], v[12:15]
    s_nop 0
    s_mov_b32 exec_lo, 0x00ff00ff
    s_mov_b32 exec_hi, 0xff00ff00
    s_nop 4
    ds_write_b128 v243, v[12:15] offset:0
    s_mov_b64 exec, -1
    s_waitcnt lgkmcnt(0)
    s_barrier
L_proj:
    ds_read_b64 v[28:29], v240 offset:0
    ds_read_b64 v[30:31], v240 offset:512
    ds_read_b64 v[32:33], v240 offset:1024
    ds_read_b64 v[34:35], v240 offset:1536
    s_waitcnt lgkmcnt(2)
    v_add_f32 v28, v28, v30
    v_add_f32 v29, v29, v31
    s_waitcnt lgkmcnt(0)
    v_add_f32 v32, v32, v34
    v_add_f32 v33, v33, v35
    v_add_f32 v28, v28, v32
    v_add_f32 v29, v29, v33
    v_cvt_pk_bf16_f32 v46, v28, 0
    v_cvt_pk_bf16_f32 v47, v29, 0
    ds_write_b64 v240, v[46:47] offset:2304
    ds_read_b128 v[36:39], v241 offset:2304
    ds_read_b128 v[40:43], v241 offset:2320
    ds_read_b128 v[4:7], v241 offset:2336
    ds_read_b128 v[12:15], v241 offset:2352
    v_mov_b32 v20, 0
    v_mov_b32 v21, 0
    v_mov_b32 v22, 0
    v_mov_b32 v23, 0
    v_mov_b32 v24, 0
    v_mov_b32 v25, 0
    v_mov_b32 v26, 0
    v_mov_b32 v27, 0
    s_waitcnt lgkmcnt(3)
    v_and_b32 v28, v36, v248
    v_and_b32 v29, v36, v249
    v_and_b32 v30, v37, v248
    v_and_b32 v31, v37, v249
    v_and_b32 v32, v38, v248
    v_and_b32 v33, v38, v249
    v_and_b32 v34, v39, v248
    v_and_b32 v35, v39, v249
    v_smfmac_f32_16x16x64_bf16 v[20:23], v[28:31], v[112:119], v250
    v_smfmac_f32_16x16x64_bf16 v[24:27], v[28:31], v[120:127], v250
    s_waitcnt lgkmcnt(2)
    v_and_b32 v28, v40, v248
    v_and_b32 v29, v40, v249
    v_and_b32 v30, v41, v248
    v_and_b32 v31, v41, v249
    v_smfmac_f32_16x16x64_bf16 v[20:23], v[32:35], v[128:135], v250
    v_smfmac_f32_16x16x64_bf16 v[24:27], v[32:35], v[136:143], v250
    v_and_b32 v32, v42, v248
    v_and_b32 v33, v42, v249
    v_and_b32 v34, v43, v248
    v_and_b32 v35, v43, v249
    v_smfmac_f32_16x16x64_bf16 v[20:23], v[28:31], v[144:151], v250
    v_smfmac_f32_16x16x64_bf16 v[24:27], v[28:31], v[152:159], v250
    s_waitcnt lgkmcnt(1)
    v_and_b32 v28, v4, v248
    v_and_b32 v29, v4, v249
    v_and_b32 v30, v5, v248
    v_and_b32 v31, v5, v249
    v_smfmac_f32_16x16x64_bf16 v[20:23], v[32:35], v[160:167], v250
    v_smfmac_f32_16x16x64_bf16 v[24:27], v[32:35], v[168:175], v250
    v_and_b32 v32, v6, v248
    v_and_b32 v33, v6, v249
    v_and_b32 v34, v7, v248
    v_and_b32 v35, v7, v249
    v_smfmac_f32_16x16x64_bf16 v[20:23], v[28:31], v[176:183], v250
    v_smfmac_f32_16x16x64_bf16 v[24:27], v[28:31], v[184:191], v250
    s_waitcnt lgkmcnt(0)
    v_and_b32 v28, v12, v248
    v_and_b32 v29, v12, v249
    v_and_b32 v30, v13, v248
    v_and_b32 v31, v13, v249
    v_smfmac_f32_16x16x64_bf16 v[20:23], v[32:35], v[192:199], v250
    v_smfmac_f32_16x16x64_bf16 v[24:27], v[32:35], v[200:207], v250
    v_and_b32 v32, v14, v248
    v_and_b32 v33, v14, v249
    v_and_b32 v34, v15, v248
    v_and_b32 v35, v15, v249
    v_smfmac_f32_16x16x64_bf16 v[20:23], v[28:31], v[208:215], v250
    v_smfmac_f32_16x16x64_bf16 v[24:27], v[28:31], v[216:223], v250
    v_smfmac_f32_16x16x64_bf16 v[20:23], v[32:35], v[224:231], v250
    v_smfmac_f32_16x16x64_bf16 v[24:27], v[32:35], v[232:239], v250
    s_nop 7
    v_permlane32_swap_b32 v20, v24
    v_permlane32_swap_b32 v21, v25
    v_permlane32_swap_b32 v22, v26
    v_permlane32_swap_b32 v23, v27
    v_add_f32_dpp v20, v24, v20 row_ror:8 row_mask:0xf bank_mask:0xf
    v_add_f32_dpp v21, v25, v21 row_ror:8 row_mask:0xf bank_mask:0xf
    v_add_f32_dpp v22, v26, v22 row_ror:8 row_mask:0xf bank_mask:0xf
    v_add_f32_dpp v23, v27, v23 row_ror:8 row_mask:0xf bank_mask:0xf
    v_cvt_pk_bf16_f32 v20, v20, v21
    v_cvt_pk_bf16_f32 v21, v22, v23
    v_min_u32 v20, -2, v20
    v_min_u32 v21, -2, v21
    s_mov_b32 exec_lo, 0x00ff00ff
    s_mov_b32 exec_hi, 0x00ff00ff
    buffer_store_dwordx2 v[20:21], v242, s[40:43], s55 offen sc1
    s_mov_b64 exec, -1
    s_cmp_eq_u32 s3, 4
    s_cbranch_scc1 L_h_projret
    s_barrier
    buffer_load_dwordx2 v[28:29], v244, s[40:43], s81 offen sc1
    ds_read_b32 v46, v240 offset:2816
    v_lshrrev_b32 v19, 3, v18
    v_add_u32 v19, s63, v19
    s_waitcnt lgkmcnt(0)
L_poll:
    s_waitcnt vmcnt(0)
    v_max_u32 v0, v28, v29
    v_cmp_eq_u32 vcc, -1, v0
    s_and_b64 exec, exec, vcc
    s_cbranch_scc0 L_pok
    buffer_load_dwordx2 v[28:29], v244, s[40:43], s81 offen sc1
    s_branch L_poll
L_pok:
    s_mov_b64 exec, -1
    v_and_b32 v31, 0xffff0000, v29
    v_lshlrev_b32 v30, 16, v29
    v_and_b32 v29, 0xffff0000, v28
    v_lshlrev_b32 v28, 16, v28
    v_mul_f32 v28, v28, v46
    v_mul_f32 v29, v29, v46
    v_mul_f32 v30, v30, v46
    v_mul_f32 v31, v31, v46
    s_nop 0
    v_permlane16_swap_b32 v28, v29
    v_permlane16_swap_b32 v30, v31
    s_nop 0
    v_add_f32 v28, v28, v29
    v_add_f32 v30, v30, v31
    s_nop 1
    v_permlane32_swap_b32 v28, v30
    s_nop 1
    v_add_f32 v28, v28, v30
    s_nop 1
    v_add_f32_dpp v28, v28, v28 row_ror:8 row_mask:0xf bank_mask:0xf
    s_nop 1
    v_add_f32_dpp v28, v28, v28 row_ror:4 row_mask:0xf bank_mask:0xf
    s_nop 1
    v_add_f32_dpp v28, v28, v28 row_ror:2 row_mask:0xf bank_mask:0xf
    s_nop 1
    v_add_f32_dpp v28, v28, v28 row_ror:1 row_mask:0xf bank_mask:0xf
    v_cvt_pk_bf16_f32 v28, v28, v28
    s_mov_b32 exec_lo, 0x00010001
    s_mov_b32 exec_hi, 0x00010001
    global_store_short v19, v28, s[24:25] nt
L_done:
    s_endpgm
L_tail_end:
L_wpiece:
    s_cmp_lg_u32 s56, 0
    s_cbranch_scc1 L_wp1
    ds_read_b128 v[112:115], v245 offset:25600
    ds_read_b128 v[120:123], v245 offset:25728
    ds_read_b128 v[116:119], v251 offset:25600
    ds_read_b128 v[124:127], v251 offset:25728
    s_branch L_vret
L_wp1:
    s_cmp_lg_u32 s56, 1
    s_cbranch_scc1 L_wp2
    ds_read_b128 v[128:131], v245 offset:27648
    ds_read_b128 v[136:139], v245 offset:27776
    ds_read_b128 v[132:135], v251 offset:27648
    ds_read_b128 v[140:143], v251 offset:27776
    s_branch L_vret
L_wp2:
    s_cmp_lg_u32 s56, 2
    s_cbranch_scc1 L_wp3
    ds_read_b128 v[144:147], v245 offset:29696
    ds_read_b128 v[152:155], v245 offset:29824
    ds_read_b128 v[148:151], v251 offset:29696
    ds_read_b128 v[156:159], v251 offset:29824
    s_branch L_vret
L_wp3:
    s_cmp_lg_u32 s56, 3
    s_cbranch_scc1 L_wp4
    ds_read_b128 v[160:163], v245 offset:31744
    ds_read_b128 v[168:171], v245 offset:31872
    ds_read_b128 v[164:167], v251 offset:31744
    ds_read_b128 v[172:175], v251 offset:31872
    s_branch L_vret
L_wp4:
    s_cmp_lg_u32 s56, 4
    s_cbranch_scc1 L_wp5
    ds_read_b128 v[176:179], v245 offset:33792
    ds_read_b128 v[184:187], v245 offset:33920
    ds_read_b128 v[180:183], v251 offset:33792
    ds_read_b128 v[188:191], v251 offset:33920
    s_branch L_vret
L_wp5:
    s_cmp_lg_u32 s56, 5
    s_cbranch_scc1 L_wp6
    ds_read_b128 v[192:195], v245 offset:35840
    ds_read_b128 v[200:203], v245 offset:35968
    ds_read_b128 v[196:199], v251 offset:35840
    ds_read_b128 v[204:207], v251 offset:35968
    s_branch L_vret
L_wp6:
    s_cmp_lg_u32 s56, 6
    s_cbranch_scc1 L_wp7
    ds_read_b128 v[208:211], v245 offset:37888
    ds_read_b128 v[216:219], v245 offset:38016
    ds_read_b128 v[212:215], v251 offset:37888
    ds_read_b128 v[220:223], v251 offset:38016
    s_branch L_vret
L_wp7:
    ds_read_b128 v[224:227], v245 offset:39936
    ds_read_b128 v[232:235], v245 offset:40064
    ds_read_b128 v[228:231], v251 offset:39936
    ds_read_b128 v[236:239], v251 offset:40064
    s_branch L_vret
L_v2k:
    v_and_b32 v19, 15, v18
    v_lshlrev_b32 v19, 4, v19
    ds_read_b128 v[4:7], v19 offset:8192
    s_mov_b32 s53, 1
    s_mov_b32 s59, 24
    s_mov_b32 s60, s8
    s_mov_b32 s61, s9
    v_mov_b32 v44, 0xff7fffff
    v_subrev_u32 v45, 1024, v45
    s_lshl_b32 s56, s3, 2
    v_mov_b32 v19, s56
    v_add_f32_dpp v2, v2, v2 row_ror:4 row_mask:0xf bank_mask:0xf
    s_nop 1
    v_add_f32_dpp v2, v2, v2 row_ror:8 row_mask:0xf bank_mask:0xf
    v_mov_b32 v20, v2
    s_nop 1
    v_permlane16_swap_b32 v2, v20
    s_nop 1
    v_add_f32 v2, v2, v20
    v_mov_b32 v20, v2
    s_nop 1
    v_permlane32_swap_b32 v2, v20
    s_nop 1
    v_add_f32 v2, v2, v20
    ds_write_b32 v19, v2 offset:2048
    s_mov_b32 exec_lo, 0x00ff00ff
    s_mov_b32 exec_hi, 0xff00ff00
    ds_write_b128 v243, v[12:15] offset:0
    s_mov_b64 exec, -1
.p2align 6
L_kloop:
    s_add_u32 s51, s51, 1
    s_cmp_eq_u32 s51, s59
    s_cselect_b32 s32, s60, s32
    s_cselect_b32 s33, s61, s33
    s_cselect_b32 s48, s62, s48
    s_barrier
    ds_read_b32 v0, v17 offset:8704
    s_waitcnt lgkmcnt(0)
    v_readfirstlane_b32 s78, v0
    s_waitcnt vmcnt(12)
    v_dot2_f32_bf16 v20, v48, v4, 0
    v_dot2_f32_bf16 v21, v52, v4, 0
    v_dot2_f32_bf16 v22, v56, v4, 0
    v_dot2_f32_bf16 v23, v60, v4, 0
    v_dot2_f32_bf16 v20, v49, v5, v20
    v_dot2_f32_bf16 v21, v53, v5, v21
    v_dot2_f32_bf16 v22, v57, v5, v22
    v_dot2_f32_bf16 v23, v61, v5, v23
    v_dot2_f32_bf16 v20, v50, v6, v20
    v_dot2_f32_bf16 v21, v54, v6, v21
    v_dot2_f32_bf16 v22, v58, v6, v22
    v_dot2_f32_bf16 v23, v62, v6, v23
    v_dot2_f32_bf16 v20, v51, v7, v20
    v_dot2_f32_bf16 v21, v55, v7, v21
    v_dot2_f32_bf16 v22, v59, v7, v22
    v_dot2_f32_bf16 v23, v63, v7, v23
    s_bitcmp1_b32 s78, 24
    s_cbranch_scc1 L_t49
    s_waitcnt vmcnt(9)
    s_bitcmp1_b32 s78, 16
    s_cbranch_scc1 L_t49
    s_waitcnt vmcnt(6)
    s_bitcmp1_b32 s78, 8
    s_cbranch_scc1 L_t49
    s_bitcmp1_b32 s78, 0
    s_cbranch_scc1 L_u49
    s_waitcnt vmcnt(3)
L_u49:
    s_waitcnt vmcnt(4)
L_t49:
    buffer_load_dwordx4 v[48:51], v1, s[32:35], s48 offen nt
    s_xor_b32 s57, s48, 9216
    s_bitcmp1_b32 s78, 25
    s_cbranch_scc1 L_t50
    s_waitcnt vmcnt(9)
    s_bitcmp1_b32 s78, 17
    s_cbranch_scc1 L_t50
    s_waitcnt vmcnt(6)
    s_bitcmp1_b32 s78, 9
    s_cbranch_scc1 L_t50
    s_bitcmp1_b32 s78, 1
    s_cbranch_scc1 L_u50
    s_waitcnt vmcnt(3)
L_u50:
    s_waitcnt vmcnt(4)
L_t50:
    buffer_load_dwordx4 v[52:55], v1, s[32:35], s57 offen nt
    s_xor_b32 s57, s48, 2048
    s_bitcmp1_b32 s78, 26
    s_cbranch_scc1 L_t51
    s_waitcnt vmcnt(9)
    s_bitcmp1_b32 s78, 18
    s_cbranch_scc1 L_t51
    s_waitcnt vmcnt(6)
    s_bitcmp1_b32 s78, 10
    s_cbranch_scc1 L_t51
    s_bitcmp1_b32 s78, 2
    s_cbranch_scc1 L_u51
    s_waitcnt vmcnt(3)
L_u51:
    s_waitcnt vmcnt(4)
L_t51:
    buffer_load_dwordx4 v[56:59], v1, s[32:35], s57 offen nt
    s_xor_b32 s57, s48, 11264
    s_bitcmp1_b32 s78, 27
    s_cbranch_scc1 L_t52
    s_waitcnt vmcnt(9)
    s_bitcmp1_b32 s78, 19
    s_cbranch_scc1 L_t52
    s_waitcnt vmcnt(6)
    s_bitcmp1_b32 s78, 11
    s_cbranch_scc1 L_t52
    s_bitcmp1_b32 s78, 3
    s_cbranch_scc1 L_u52
    s_waitcnt vmcnt(3)
L_u52:
    s_waitcnt vmcnt(4)
L_t52:
    buffer_load_dwordx4 v[60:63], v1, s[32:35], s57 offen nt
    s_waitcnt vmcnt(12)
    v_dot2_f32_bf16 v24, v64, v4, 0
    v_dot2_f32_bf16 v25, v68, v4, 0
    v_dot2_f32_bf16 v26, v72, v4, 0
    v_dot2_f32_bf16 v27, v76, v4, 0
    v_dot2_f32_bf16 v24, v65, v5, v24
    v_dot2_f32_bf16 v25, v69, v5, v25
    v_dot2_f32_bf16 v26, v73, v5, v26
    v_dot2_f32_bf16 v27, v77, v5, v27
    v_dot2_f32_bf16 v24, v66, v6, v24
    v_dot2_f32_bf16 v25, v70, v6, v25
    v_dot2_f32_bf16 v26, v74, v6, v26
    v_dot2_f32_bf16 v27, v78, v6, v27
    v_dot2_f32_bf16 v24, v67, v7, v24
    v_dot2_f32_bf16 v25, v71, v7, v25
    v_dot2_f32_bf16 v26, v75, v7, v26
    v_dot2_f32_bf16 v27, v79, v7, v27
    s_xor_b32 s57, s48, 16384
    s_bitcmp1_b32 s78, 28
    s_cbranch_scc1 L_t53
    s_waitcnt vmcnt(9)
    s_bitcmp1_b32 s78, 20
    s_cbranch_scc1 L_t53
    s_waitcnt vmcnt(6)
    s_bitcmp1_b32 s78, 12
    s_cbranch_scc1 L_t53
    s_bitcmp1_b32 s78, 4
    s_cbranch_scc1 L_u53
    s_waitcnt vmcnt(3)
L_u53:
    s_waitcnt vmcnt(4)
L_t53:
    buffer_load_dwordx4 v[64:67], v1, s[32:35], s57 offen nt
    s_xor_b32 s57, s48, 25600
    s_bitcmp1_b32 s78, 29
    s_cbranch_scc1 L_t54
    s_waitcnt vmcnt(9)
    s_bitcmp1_b32 s78, 21
    s_cbranch_scc1 L_t54
    s_waitcnt vmcnt(6)
    s_bitcmp1_b32 s78, 13
    s_cbranch_scc1 L_t54
    s_bitcmp1_b32 s78, 5
    s_cbranch_scc1 L_u54
    s_waitcnt vmcnt(3)
L_u54:
    s_waitcnt vmcnt(4)
L_t54:
    buffer_load_dwordx4 v[68:71], v1, s[32:35], s57 offen nt
    s_xor_b32 s57, s48, 18432
    s_bitcmp1_b32 s78, 30
    s_cbranch_scc1 L_t55
    s_waitcnt vmcnt(9)
    s_bitcmp1_b32 s78, 22
    s_cbranch_scc1 L_t55
    s_waitcnt vmcnt(6)
    s_bitcmp1_b32 s78, 14
    s_cbranch_scc1 L_t55
    s_bitcmp1_b32 s78, 6
    s_cbranch_scc1 L_u55
    s_waitcnt vmcnt(3)
L_u55:
    s_waitcnt vmcnt(4)
L_t55:
    buffer_load_dwordx4 v[72:75], v1, s[32:35], s57 offen nt
    s_xor_b32 s57, s48, 27648
    s_bitcmp1_b32 s78, 31
    s_cbranch_scc1 L_t56
    s_waitcnt vmcnt(9)
    s_bitcmp1_b32 s78, 23
    s_cbranch_scc1 L_t56
    s_waitcnt vmcnt(6)
    s_bitcmp1_b32 s78, 15
    s_cbranch_scc1 L_t56
    s_bitcmp1_b32 s78, 7
    s_cbranch_scc1 L_u56
    s_waitcnt vmcnt(3)
L_u56:
    s_waitcnt vmcnt(4)
L_t56:
    buffer_load_dwordx4 v[76:79], v1, s[32:35], s57 offen nt
    s_barrier
    ds_read_b32 v0, v17 offset:8704
    s_waitcnt lgkmcnt(0)
    v_readfirstlane_b32 s78, v0
    s_waitcnt vmcnt(12)
    v_dot2_f32_bf16 v28, v80, v4, 0
    v_dot2_f32_bf16 v29, v84, v4, 0
    v_dot2_f32_bf16 v30, v88, v4, 0
    v_dot2_f32_bf16 v31, v92, v4, 0
    v_dot2_f32_bf16 v28, v81, v5, v28
    v_dot2_f32_bf16 v29, v85, v5, v29
    v_dot2_f32_bf16 v30, v89, v5, v30
    v_dot2_f32_bf16 v31, v93, v5, v31
    v_dot2_f32_bf16 v28, v82, v6, v28
    v_dot2_f32_bf16 v29, v86, v6, v29
    v_dot2_f32_bf16 v30, v90, v6, v30
    v_dot2_f32_bf16 v31, v94, v6, v31
    v_dot2_f32_bf16 v28, v83, v7, v28
    v_dot2_f32_bf16 v29, v87, v7, v29
    v_dot2_f32_bf16 v30, v91, v7, v30
    v_dot2_f32_bf16 v31, v95, v7, v31
    s_bitcmp1_b32 s78, 24
    s_cbranch_scc1 L_t57
    s_waitcnt vmcnt(9)
    s_bitcmp1_b32 s78, 16
    s_cbranch_scc1 L_t57
    s_waitcnt vmcnt(6)
    s_bitcmp1_b32 s78, 8
    s_cbranch_scc1 L_t57
    s_bitcmp1_b32 s78, 0
    s_cbranch_scc1 L_u57
    s_waitcnt vmcnt(3)
L_u57:
    s_waitcnt vmcnt(4)
L_t57:
    buffer_load_dwordx4 v[80:83], v246, s[32:35], s48 offen nt
    s_xor_b32 s57, s48, 9216
    s_bitcmp1_b32 s78, 25
    s_cbranch_scc1 L_t58
    s_waitcnt vmcnt(9)
    s_bitcmp1_b32 s78, 17
    s_cbranch_scc1 L_t58
    s_waitcnt vmcnt(6)
    s_bitcmp1_b32 s78, 9
    s_cbranch_scc1 L_t58
    s_bitcmp1_b32 s78, 1
    s_cbranch_scc1 L_u58
    s_waitcnt vmcnt(3)
L_u58:
    s_waitcnt vmcnt(4)
L_t58:
    buffer_load_dwordx4 v[84:87], v246, s[32:35], s57 offen nt
    v_add_f32_dpp v20, v28, v20 row_ror:8 row_mask:0xf bank_mask:0xf
    v_add_f32_dpp v21, v29, v21 row_ror:8 row_mask:0xf bank_mask:0xf
    v_add_f32_dpp v22, v30, v22 row_ror:8 row_mask:0xf bank_mask:0xf
    v_add_f32_dpp v23, v31, v23 row_ror:8 row_mask:0xf bank_mask:0xf
    v_add_f32_dpp v20, v20, v20 row_half_mirror row_mask:0xf bank_mask:0x5
    v_add_f32_dpp v20, v21, v21 row_half_mirror row_mask:0xf bank_mask:0xa
    v_add_f32_dpp v22, v22, v22 row_half_mirror row_mask:0xf bank_mask:0x5
    v_add_f32_dpp v22, v23, v23 row_half_mirror row_mask:0xf bank_mask:0xa
    v_add_f32_dpp v20, v20, v20 quad_perm:[1,0,3,2] row_mask:0xf bank_mask:0xf
    s_nop 0
    v_add_f32_dpp v22, v22, v22 quad_perm:[1,0,3,2] row_mask:0xf bank_mask:0xf
    v_add_f32_dpp v20, v20, v20 quad_perm:[2,3,0,1] row_mask:0xf bank_mask:0xf
    s_nop 0
    v_add_f32_dpp v22, v22, v22 quad_perm:[2,3,0,1] row_mask:0xf bank_mask:0xf
    ds_write_b32 v45, v20 offset:9216
    v_max3_f32 v44, v44, v20, v22
    ds_write_b32 v45, v22 offset:9280
    s_xor_b32 s57, s48, 2048
    s_bitcmp1_b32 s78, 26
    s_cbranch_scc1 L_t59
    s_waitcnt vmcnt(9)
    s_bitcmp1_b32 s78, 18
    s_cbranch_scc1 L_t59
    s_waitcnt vmcnt(6)
    s_bitcmp1_b32 s78, 10
    s_cbranch_scc1 L_t59
    s_bitcmp1_b32 s78, 2
    s_cbranch_scc1 L_u59
    s_waitcnt vmcnt(3)
L_u59:
    s_waitcnt vmcnt(4)
L_t59:
    buffer_load_dwordx4 v[88:91], v246, s[32:35], s57 offen nt
    s_xor_b32 s57, s48, 11264
    s_bitcmp1_b32 s78, 27
    s_cbranch_scc1 L_t60
    s_waitcnt vmcnt(9)
    s_bitcmp1_b32 s78, 19
    s_cbranch_scc1 L_t60
    s_waitcnt vmcnt(6)
    s_bitcmp1_b32 s78, 11
    s_cbranch_scc1 L_t60
    s_bitcmp1_b32 s78, 3
    s_cbranch_scc1 L_u60
    s_waitcnt vmcnt(3)
L_u60:
    s_waitcnt vmcnt(4)
L_t60:
    buffer_load_dwordx4 v[92:95], v246, s[32:35], s57 offen nt
    s_waitcnt vmcnt(12)
    v_dot2_f32_bf16 v32, v96, v4, 0
    v_dot2_f32_bf16 v33, v100, v4, 0
    v_dot2_f32_bf16 v34, v104, v4, 0
    v_dot2_f32_bf16 v35, v108, v4, 0
    v_dot2_f32_bf16 v32, v97, v5, v32
    v_dot2_f32_bf16 v33, v101, v5, v33
    v_dot2_f32_bf16 v34, v105, v5, v34
    v_dot2_f32_bf16 v35, v109, v5, v35
    v_dot2_f32_bf16 v32, v98, v6, v32
    v_dot2_f32_bf16 v33, v102, v6, v33
    v_dot2_f32_bf16 v34, v106, v6, v34
    v_dot2_f32_bf16 v35, v110, v6, v35
    v_dot2_f32_bf16 v32, v99, v7, v32
    v_dot2_f32_bf16 v33, v103, v7, v33
    v_dot2_f32_bf16 v34, v107, v7, v34
    v_dot2_f32_bf16 v35, v111, v7, v35
    s_xor_b32 s57, s48, 16384
    s_bitcmp1_b32 s78, 28
    s_cbranch_scc1 L_t61
    s_waitcnt vmcnt(9)
    s_bitcmp1_b32 s78, 20
    s_cbranch_scc1 L_t61
    s_waitcnt vmcnt(6)
    s_bitcmp1_b32 s78, 12
    s_cbranch_scc1 L_t61
    s_bitcmp1_b32 s78, 4
    s_cbranch_scc1 L_u61
    s_waitcnt vmcnt(3)
L_u61:
    s_waitcnt vmcnt(4)
L_t61:
    buffer_load_dwordx4 v[96:99], v246, s[32:35], s57 offen nt
    s_xor_b32 s57, s48, 25600
    s_bitcmp1_b32 s78, 29
    s_cbranch_scc1 L_t62
    s_waitcnt vmcnt(9)
    s_bitcmp1_b32 s78, 21
    s_cbranch_scc1 L_t62
    s_waitcnt vmcnt(6)
    s_bitcmp1_b32 s78, 13
    s_cbranch_scc1 L_t62
    s_bitcmp1_b32 s78, 5
    s_cbranch_scc1 L_u62
    s_waitcnt vmcnt(3)
L_u62:
    s_waitcnt vmcnt(4)
L_t62:
    buffer_load_dwordx4 v[100:103], v246, s[32:35], s57 offen nt
    v_add_f32_dpp v24, v32, v24 row_ror:8 row_mask:0xf bank_mask:0xf
    v_add_f32_dpp v25, v33, v25 row_ror:8 row_mask:0xf bank_mask:0xf
    v_add_f32_dpp v26, v34, v26 row_ror:8 row_mask:0xf bank_mask:0xf
    v_add_f32_dpp v27, v35, v27 row_ror:8 row_mask:0xf bank_mask:0xf
    v_add_f32_dpp v24, v24, v24 row_half_mirror row_mask:0xf bank_mask:0x5
    v_add_f32_dpp v24, v25, v25 row_half_mirror row_mask:0xf bank_mask:0xa
    v_add_f32_dpp v26, v26, v26 row_half_mirror row_mask:0xf bank_mask:0x5
    v_add_f32_dpp v26, v27, v27 row_half_mirror row_mask:0xf bank_mask:0xa
    v_add_f32_dpp v24, v24, v24 quad_perm:[1,0,3,2] row_mask:0xf bank_mask:0xf
    s_nop 0
    v_add_f32_dpp v26, v26, v26 quad_perm:[1,0,3,2] row_mask:0xf bank_mask:0xf
    v_add_f32_dpp v24, v24, v24 quad_perm:[2,3,0,1] row_mask:0xf bank_mask:0xf
    s_nop 0
    v_add_f32_dpp v26, v26, v26 quad_perm:[2,3,0,1] row_mask:0xf bank_mask:0xf
    ds_write_b32 v45, v24 offset:9344
    v_max3_f32 v44, v44, v24, v26
    ds_write_b32 v45, v26 offset:9408
    s_xor_b32 s57, s48, 18432
    s_bitcmp1_b32 s78, 30
    s_cbranch_scc1 L_t63
    s_waitcnt vmcnt(9)
    s_bitcmp1_b32 s78, 22
    s_cbranch_scc1 L_t63
    s_waitcnt vmcnt(6)
    s_bitcmp1_b32 s78, 14
    s_cbranch_scc1 L_t63
    s_bitcmp1_b32 s78, 6
    s_cbranch_scc1 L_u63
    s_waitcnt vmcnt(3)
L_u63:
    s_waitcnt vmcnt(4)
L_t63:
    buffer_load_dwordx4 v[104:107], v246, s[32:35], s57 offen nt
    s_xor_b32 s57, s48, 27648
    s_bitcmp1_b32 s78, 31
    s_cbranch_scc1 L_t64
    s_waitcnt vmcnt(9)
    s_bitcmp1_b32 s78, 23
    s_cbranch_scc1 L_t64
    s_waitcnt vmcnt(6)
    s_bitcmp1_b32 s78, 15
    s_cbranch_scc1 L_t64
    s_bitcmp1_b32 s78, 7
    s_cbranch_scc1 L_u64
    s_waitcnt vmcnt(3)
L_u64:
    s_waitcnt vmcnt(4)
L_t64:
    buffer_load_dwordx4 v[108:111], v246, s[32:35], s57 offen nt
    s_add_u32 s48, s48, 0x10000
    v_add_u32 v45, 256, v45
    s_cmp_lt_u32 s51, s59
    s_cbranch_scc1 L_kloop
    s_mov_b32 s53, 2
    s_mov_b32 s59, 39
    s_add_u32 s62, s49, 983040
    s_branch L_k2v
L_helper:
    s_setprio 0
    v_lshrrev_b32 v17, 6, v0
    v_and_b32 v18, 63, v0
    v_readfirstlane_b32 s3, v17
    s_bfe_u32 s44, s2, 0x30003
    s_lshr_b32 s46, s44, 1
    s_and_b32 s47, s44, 1
    s_mov_b32 s34, 0x10000000
    s_mov_b32 s35, 0x20000
    s_mov_b32 s42, 0x400000
    s_mov_b32 s43, 0x20000
    v_mov_b32 v17, 0
    s_lshl_b32 s55, s46, 5
    s_add_u32 s55, s55, s45
    s_lshl1_add_u32 s81, s55, s47
    s_mul_i32 s55, s81, 1152
    s_add_u32 s55, s55, 1048576
    v_mov_b32 v0, 22015
    ds_write_b32 v17, v0 offset:8704
    v_mov_b32 v28, -1
    v_mov_b32 v29, -1
    v_mov_b32 v30, -1
    v_mov_b32 v31, -1
    v_lshlrev_b32 v1, 4, v18
    s_waitcnt lgkmcnt(0)
    s_mov_b32 s40, s28
    s_mov_b32 s41, s29
    s_mov_b32 s36, s22
    s_mov_b32 s37, s23
    s_lshl_b32 s56, s81, 20
    s_or_b32 s57, s56, 0x180000
    s_cmp_eq_u32 s47, 0
    s_cselect_b64 s[88:89], s[16:17], s[18:19]
    s_cselect_b64 s[90:91], s[6:7], s[8:9]
    s_load_dword s92, s[88:89], s57
    s_load_dword s93, s[90:91], s56
    s_cmp_lg_u32 s2, 0
    s_cbranch_scc1 L_h_noinit
    v_lshlrev_b32 v19, 8, v18
    s_mov_b32 exec_hi, 0
    s_mov_b32 s56, 0
    buffer_store_dword v17, v19, s[40:43], s56 offen sc1
    s_waitcnt vmcnt(0)
    s_mov_b64 exec, -1
    s_mov_b32 s64, 1
    s_atomic_add s64, s[26:27], 0
L_h_noinit:
    s_lshl_b32 s56, s2, 8
    s_add_u32 s56, s56, 8192
    s_mov_b64 exec, 1
    buffer_store_dword v17, v17, s[40:43], s56 offen sc1
    s_mov_b64 exec, -1
    buffer_store_dwordx4 v[28:31], v1, s[40:43], s55 offen sc1
    s_mov_b64 exec, 0xff
    buffer_store_dwordx4 v[28:31], v1, s[40:43], s55 offen offset:1024 sc1
    s_mov_b64 exec, -1
    s_add_u32 s55, s55, 294912
    s_mov_b64 exec, 0xff
    buffer_store_dwordx4 v[28:31], v1, s[40:43], s55 offen offset:1024 sc1
    s_mov_b64 exec, -1
    v_and_b32 v0, 1, v18
    v_lshlrev_b32 v0, 4, v0
    v_mov_b32 v19, 0xffff
    v_lshlrev_b32 v0, v0, v19
    v_bfe_u32 v19, v18, 1, 2
    v_cmp_eq_u32 vcc, 0, v19
    s_nop 1
    v_cndmask_b32 v8, 0, v0, vcc
    v_cmp_eq_u32 vcc, 1, v19
    s_nop 1
    v_cndmask_b32 v9, 0, v0, vcc
    v_cmp_eq_u32 vcc, 2, v19
    s_nop 1
    v_cndmask_b32 v10, 0, v0, vcc
    v_cmp_eq_u32 vcc, 3, v19
    s_nop 1
    v_cndmask_b32 v11, 0, v0, vcc
    v_lshlrev_b32 v240, 3, v18
    v_lshrrev_b32 v0, 3, v18
    v_lshlrev_b32 v241, 6, v0
    v_and_b32 v0, 1, v0
    v_lshrrev_b32 v19, 5, v18
    v_lshl_add_u32 v0, v19, 1, v0
    v_mul_u32_u24 v245, 16512, v0
    v_bfe_u32 v0, v18, 4, 1
    v_lshl_add_u32 v245, v0, 10, v245
    v_bfe_i32 v249, v18, 2, 1
    v_not_b32 v248, v249
    v_and_b32 v250, 3, v18
    v_mul_u32_u24 v250, 0x5555, v250
    v_and_b32 v19, 7, v18
    v_lshl_add_u32 v245, v19, 4, v245
    v_lshlrev_b32 v242, 3, v19
    v_lshrrev_b32 v0, 4, v18
    v_lshl_add_u32 v242, v0, 6, v242
    v_and_b32 v19, 16, v18
    v_add_u32 v251, 66048, v245
    s_lshl_b32 s48, s45, 14
    s_add_u32 s48, s48, 262144
    s_lshl_b32 s57, s44, 11
    s_add_u32 s57, s57, s48
    s_lshl_b32 s62, s45, 8
    v_and_b32 v19, 31, v18
    v_lshlrev_b32 v46, 3, v19
    v_lshlrev_b32 v244, 8, v19
    v_lshlrev_b32 v19, 4, v19
    v_lshrrev_b32 v0, 5, v18
    v_lshl_add_u32 v19, v0, 11, v19
    s_lshl_b32 s56, s46, 9
    v_add_u32 v19, s56, v19
    v_lshl_add_u32 v46, v0, 8, v46
    v_mov_b32 v47, s62
    s_barrier
    ds_read_b128 v[48:51], v1 offset:0
    ds_read_b128 v[52:55], v1 offset:1024
    ds_read_b128 v[56:59], v1 offset:2048
    ds_read_b128 v[60:63], v1 offset:3072
    ds_read_b128 v[64:67], v1 offset:4096
    ds_read_b128 v[68:71], v1 offset:5120
    ds_read_b128 v[72:75], v1 offset:6144
    ds_read_b128 v[76:79], v1 offset:7168
    global_load_dword v0, v17, s[26:27] sc1
    s_waitcnt lgkmcnt(0)
    v_add_f32 v48, v48, v64
    v_add_f32 v49, v49, v65
    v_add_f32 v50, v50, v66
    v_add_f32 v51, v51, v67
    v_add_f32 v52, v52, v68
    v_add_f32 v53, v53, v69
    v_add_f32 v54, v54, v70
    v_add_f32 v55, v55, v71
    v_add_f32 v56, v56, v72
    v_add_f32 v57, v57, v73
    v_add_f32 v58, v58, v74
    v_add_f32 v59, v59, v75
    v_add_f32 v60, v60, v76
    v_add_f32 v61, v61, v77
    v_add_f32 v62, v62, v78
    v_add_f32 v63, v63, v79
    v_add_f32 v48, v48, v56
    v_add_f32 v49, v49, v57
    v_add_f32 v50, v50, v58
    v_add_f32 v51, v51, v59
    v_add_f32 v52, v52, v60
    v_add_f32 v53, v53, v61
    v_add_f32 v54, v54, v62
    v_add_f32 v55, v55, v63
    buffer_store_dwordx4 v[48:51], v1, s[40:43], s57 offen sc1
    buffer_store_dwordx4 v[52:55], v1, s[40:43], s57 offen offset:1024 sc1
    s_waitcnt vmcnt(0)
L_h_flag:
    v_cmp_ne_u32 vcc, 0, v0
    s_cbranch_vccnz L_h_flagok
    global_load_dword v0, v17, s[26:27] sc1
    s_waitcnt vmcnt(0)
    s_branch L_h_flag
L_h_flagok:
    s_mov_b32 s65, 1
    s_atomic_add s65, s[28:29], s62 glc
    s_waitcnt lgkmcnt(0)
    s_cmp_eq_u32 s65, 7
    s_cbranch_scc1 L_h_qcok
L_h_qc:
L_h_qc1:
    s_load_dword s65, s[28:29], s62 glc
    s_waitcnt lgkmcnt(0)
    s_cmp_lg_u32 s65, 8
    s_cbranch_scc1 L_h_qc
L_h_qcok:
    buffer_load_dwordx4 v[48:51], v19, s[40:43], s48 offen sc1
    s_add_u32 s48, s48, 4096
    buffer_load_dwordx4 v[52:55], v19, s[40:43], s48 offen sc1
    s_add_u32 s48, s48, 4096
    buffer_load_dwordx4 v[56:59], v19, s[40:43], s48 offen sc1
    s_add_u32 s48, s48, 4096
    buffer_load_dwordx4 v[60:63], v19, s[40:43], s48 offen sc1
    s_waitcnt vmcnt(0)
    v_add_f32 v48, v48, v52
    v_add_f32 v49, v49, v53
    v_add_f32 v50, v50, v54
    v_add_f32 v51, v51, v55
    v_add_f32 v56, v56, v60
    v_add_f32 v57, v57, v61
    v_add_f32 v58, v58, v62
    v_add_f32 v59, v59, v63
    s_nop 1
    v_permlane32_swap_b32 v48, v56
    v_permlane32_swap_b32 v49, v57
    v_permlane32_swap_b32 v50, v58
    v_permlane32_swap_b32 v51, v59
    s_nop 1
    v_add_f32 v48, v48, v56
    v_add_f32 v49, v49, v57
    v_add_f32 v50, v50, v58
    v_add_f32 v51, v51, v59
    v_cvt_pk_bf16_f32 v48, v48, v49
    v_cvt_pk_bf16_f32 v49, v50, v51
    ds_write_b64 v46, v[48:49] offset:8192
    s_mov_b32 s51, 3
    s_mov_b32 s86, 1431655760
    s_mov_b32 s87, 253
    s_mov_b32 s65, 0
    s_mov_b32 s49, 0
    s_mov_b32 s50, 0
    s_mov_b32 s54, 0
    s_mov_b32 s85, 0
    v_mov_b32 v247, 0
    v_mov_b32 v246, 0
    s_lshl_b32 s81, s81, 8
    s_bitset1_b32 s81, 31
    v_and_b32 v243, 31, v18
    v_lshlrev_b32 v45, 7, v243
    v_lshlrev_b32 v243, 2, v243
    s_lshr_b32 s62, s2, 3
    s_and_b32 s63, s2, 7
    s_mov_b32 s79, 120
    s_mov_b32 s78, 0
    s_mov_b32 s91, 0
    s_mov_b32 s84, -3
    s_mov_b32 s60, 2760409088
    s_mov_b32 s61, 4277066410
    s_lshl_b32 s48, s45, 17
    s_mov_b32 s80, 25600
    s_waitcnt lgkmcnt(0)
L_h_loop:
    s_barrier
    s_cmp_lg_u32 s51, 3
    s_cbranch_scc1 L_h_c0
    buffer_load_dword v44, v244, s[40:43], 0 offen sc1
L_h_c0:
    global_load_dword v246, v243, s[26:27] offset:128 sc1
    s_bitcmp0_b64 s[86:87], s51
    s_cbranch_scc1 L_h_nocp
    s_add_u32 s56, s65, 0
    s_mul_i32 s57, s56, s63
    s_add_u32 s57, s57, s62
    s_and_b32 s57, s57, 31
    s_lshr_b32 s93, s57, 3
    s_xor_b32 s93, s93, s56
    s_and_b32 s93, s93, 3
    s_and_b32 s57, s57, 7
    s_lshl_b32 s59, s56, 3
    s_add_u32 s57, s57, s59
    s_mul_i32 s57, s57, 9472
    s_and_b32 s57, s57, 0xff00
    s_add_u32 s57, s57, 8192
    s_lshr_b32 s59, s56, 5
    s_lshl_b32 s59, s59, 3
    s_cmp_eq_u32 s93, 0
    s_cselect_b32 s93, 7, 8
    s_cbranch_scc1 L_h_wr
    s_load_dword s58, s[28:29], s57 glc
    s_branch L_h_rd
L_h_wr:
    s_mov_b32 s58, 1
    s_atomic_add s58, s[28:29], s57 glc
L_h_rd:
    s_cmp_lt_i32 s85, 7
    s_cbranch_scc1 L_h_nocp
    s_sub_u32 s56, s51, 8
    s_cmp_ge_u32 s56, 25
    s_cbranch_scc1 L_h_nocp
    s_add_u32 s56, s65, 1
    s_mul_i32 s92, s56, s63
    s_add_u32 s92, s92, s62
    s_and_b32 s92, s92, 31
    s_and_b32 s92, s92, 7
    s_lshl_b32 s50, s56, 3
    s_add_u32 s92, s92, s50
    s_mul_i32 s92, s92, 9472
    s_and_b32 s92, s92, 0xff00
    s_add_u32 s92, s92, 8192
    s_lshr_b32 s50, s56, 5
    s_lshl_b32 s50, s50, 3
    s_load_dword s49, s[28:29], s92 glc
L_h_nocp:
    s_cmp_lg_u32 s51, 18
    s_cbranch_scc1 L_h_nosw
    s_mov_b32 s36, s12
    s_mov_b32 s37, s13
    s_lshl_b32 s48, s45, 17
    s_mov_b32 s80, 25600
L_h_nosw:
    s_sub_u32 s56, s51, 4
    s_cmp_lt_u32 s56, 8
    s_cselect_b32 s53, 1, 0
    s_sub_u32 s56, s51, 18
    s_cmp_lt_u32 s56, 8
    s_cselect_b32 s53, 1, s53
    s_cmp_eq_u32 s53, 0
    s_cbranch_scc1 L_h_d1
    s_mov_b32 m0, s80
    s_add_u32 s80, s80, 4096
    buffer_load_dwordx4 v1, s[36:39], s48 offen offset:0 nt lds
    buffer_load_dwordx4 v1, s[36:39], s48 offen offset:1024 nt lds
    buffer_load_dwordx4 v1, s[36:39], s48 offen offset:2048 nt lds
    buffer_load_dwordx4 v1, s[36:39], s48 offen offset:3072 nt lds
    s_add_u32 s48, s48, 4096
    s_mov_b32 m0, s80
    s_add_u32 s80, s80, 4096
    buffer_load_dwordx4 v1, s[36:39], s48 offen offset:0 nt lds
    buffer_load_dwordx4 v1, s[36:39], s48 offen offset:1024 nt lds
    buffer_load_dwordx4 v1, s[36:39], s48 offen offset:2048 nt lds
    buffer_load_dwordx4 v1, s[36:39], s48 offen offset:3072 nt lds
    s_add_u32 s48, s48, 4096
L_h_d1:
    s_sub_u32 s52, s51, 13
    s_cmp_ge_u32 s52, 4
    s_cbranch_scc1 L_h_now
    ds_read_b128 v[112:115], v245 offset:25600
    ds_read_b128 v[120:123], v245 offset:25728
    ds_read_b128 v[116:119], v251 offset:25600
    ds_read_b128 v[124:127], v251 offset:25728
    ds_read_b128 v[128:131], v245 offset:27648
    ds_read_b128 v[136:139], v245 offset:27776
    ds_read_b128 v[132:135], v251 offset:27648
    ds_read_b128 v[140:143], v251 offset:27776
    ds_read_b128 v[144:147], v245 offset:29696
    ds_read_b128 v[152:155], v245 offset:29824
    ds_read_b128 v[148:151], v251 offset:29696
    ds_read_b128 v[156:159], v251 offset:29824
    ds_read_b128 v[160:163], v245 offset:31744
    ds_read_b128 v[168:171], v245 offset:31872
    ds_read_b128 v[164:167], v251 offset:31744
    ds_read_b128 v[172:175], v251 offset:31872
    ds_read_b128 v[176:179], v245 offset:33792
    ds_read_b128 v[184:187], v245 offset:33920
    ds_read_b128 v[180:183], v251 offset:33792
    ds_read_b128 v[188:191], v251 offset:33920
    ds_read_b128 v[192:195], v245 offset:35840
    ds_read_b128 v[200:203], v245 offset:35968
    ds_read_b128 v[196:199], v251 offset:35840
    ds_read_b128 v[204:207], v251 offset:35968
    ds_read_b128 v[208:211], v245 offset:37888
    ds_read_b128 v[216:219], v245 offset:38016
    ds_read_b128 v[212:215], v251 offset:37888
    ds_read_b128 v[220:223], v251 offset:38016
    ds_read_b128 v[224:227], v245 offset:39936
    ds_read_b128 v[232:235], v245 offset:40064
    ds_read_b128 v[228:231], v251 offset:39936
    ds_read_b128 v[236:239], v251 offset:40064
L_h_now:
    s_barrier
    s_waitcnt vmcnt(8)
    s_cmp_lg_u32 s53, 0
    s_cbranch_scc1 L_h_mb
    s_waitcnt vmcnt(0)
L_h_mb:
    s_cmp_eq_u32 s53, 0
    s_cbranch_scc1 L_h_d2
    s_mov_b32 m0, s80
    s_add_u32 s80, s80, 4096
    buffer_load_dwordx4 v1, s[36:39], s48 offen offset:0 nt lds
    buffer_load_dwordx4 v1, s[36:39], s48 offen offset:1024 nt lds
    buffer_load_dwordx4 v1, s[36:39], s48 offen offset:2048 nt lds
    buffer_load_dwordx4 v1, s[36:39], s48 offen offset:3072 nt lds
    s_add_u32 s48, s48, 4096
    s_mov_b32 m0, s80
    s_add_u32 s80, s80, 4224
    buffer_load_dwordx4 v1, s[36:39], s48 offen offset:0 nt lds
    buffer_load_dwordx4 v1, s[36:39], s48 offen offset:1024 nt lds
    buffer_load_dwordx4 v1, s[36:39], s48 offen offset:2048 nt lds
    buffer_load_dwordx4 v1, s[36:39], s48 offen offset:3072 nt lds
    s_add_u32 s48, s48, 4096
L_h_d2:
    s_waitcnt lgkmcnt(0)
    s_bitcmp0_b64 s[86:87], s51
    s_cbranch_scc1 L_h_noctl
    s_waitcnt lgkmcnt(0)
    s_sub_i32 s56, s49, s50
    s_cmp_lt_i32 s56, 7
    s_cbranch_scc1 L_h_norq
    s_mov_b32 s78, 16
    s_cmp_ge_u32 s51, 24
    s_cselect_b32 s56, 2, 1
    s_cmp_lt_u32 s51, 8
    s_cselect_b32 s56, 0, s56
    s_cmp_le_u32 s56, s54
    s_cbranch_scc1 L_h_norq
    s_mov_b32 s54, s56
    s_lshl_b32 s57, s56, 2
    s_mov_b32 s49, 1
    s_atomic_add s49, s[26:27], s57 glc
    s_waitcnt lgkmcnt(0)
    s_cmp_ge_u32 s49, 16
    s_cbranch_scc1 L_h_norq
    s_add_u32 s56, s56, 1
    s_lshl_b32 s56, s56, 4
    s_add_u32 s49, s49, s56
    s_lshl_b32 s57, s49, 2
    s_or_b32 s49, s81, s51
    s_atomic_or s49, s[26:27], s57 glc
    s_waitcnt lgkmcnt(0)
L_h_norq:
    s_mov_b32 s49, 0
    s_mov_b32 s50, 0
    s_waitcnt lgkmcnt(0)
    s_sub_u32 s58, s58, s59
    s_lshl_b32 s58, s58, 1
    s_sub_i32 s58, s58, s93
    s_mov_b32 s85, s58
    s_mul_i32 s56, s58, 2
    s_add_i32 s79, s79, s56
    s_min_i32 s79, s79, 632
    s_max_i32 s79, s79, -392
    s_mul_i32 s56, s58, 40
    s_add_i32 s56, s56, s79
    s_ashr_i32 s56, s56, 6
    s_max_i32 s56, s56, 0
    s_min_i32 s56, s56, 8
    s_cmp_ge_i32 s58, 7
    s_cselect_b32 s59, 4, 0
    s_cmp_lt_i32 s58, 0
    s_cselect_b32 s59, -6, s59
    s_add_i32 s78, s78, s59
    s_max_i32 s78, s78, -12
    s_min_i32 s78, s78, 16
    s_max_i32 s59, s78, 0
    s_add_i32 s56, s56, s59
    s_min_i32 s56, s56, 24
    s_cmp_le_i32 s58, -5
    s_cselect_b32 s59, 1, 0
    s_cmp_gt_i32 s58, 0
    s_cselect_b32 s59, -8, s59
    s_add_i32 s84, s84, s59
    s_max_i32 s84, s84, -3
    s_min_i32 s84, s84, 8
    s_max_i32 s59, s84, 0
    s_sub_i32 s56, s56, s59
    s_add_i32 s56, s56, 8
    s_min_i32 s56, s56, 31
    s_max_i32 s56, s56, 0
    s_and_b32 s58, s56, 7
    s_lshl_b32 s58, s58, 3
    s_lshr_b64 s[30:31], s[60:61], s58
    s_and_b32 s30, s30, 0xff
    s_add_u32 s30, s30, 1
    s_andn2_b32 s56, s56, 7
    s_lshl_b32 s58, s30, s56
    s_sub_u32 s58, s58, 1
    v_mov_b32 v0, s58
    ds_write_b32 v17, v0 offset:8704
    s_waitcnt lgkmcnt(0)
L_h_noctl:
    s_cmp_lt_u32 s52, 4
    s_cbranch_scc1 L_proj
    s_branch L_h_nop
L_h_projret:
    v_add_u32 v245, 256, v245
    v_add_u32 v251, 256, v251
    v_add_u32 v242, 256, v242
L_h_nop:
    s_cmp_lg_u32 s51, 3
    s_cbranch_scc1 L_h_chkok
L_h_chk:
    s_waitcnt vmcnt(0)
    v_cmp_ne_u32 vcc, 8, v44
    s_cbranch_vccz L_h_chkok
    buffer_load_dword v44, v244, s[40:43], 0 offen sc1
    s_branch L_h_chk
L_h_chkok:
    s_cmp_lg_u32 s51, 17
    s_cbranch_scc1 L_h_n2
    s_waitcnt vmcnt(0)
    ds_read_b128 v[20:23], v17 offset:2048
    ds_read_b128 v[24:27], v17 offset:2064
    s_waitcnt lgkmcnt(0)
    v_add_f32 v20, v20, v21
    v_add_f32 v22, v22, v23
    v_max3_f32 v3, v24, v25, v26
    v_add_f32 v2, v20, v22
    v_max_f32 v3, v3, v27
    v_and_b32 v2, -2, v2
    v_and_b32 v3, -2, v3
    s_mov_b64 exec, 65535
    buffer_store_dwordx2 v[2:3], v240, s[40:43], s55 offen offset:1024 sc1
    s_mov_b64 exec, -1
L_h_n2:
    v_cmp_ne_u32 vcc, v246, v247
    v_mov_b32 v247, v246
    s_mov_b32 s30, vcc_lo
    s_mov_b32 exec_hi, 0
L_h_srv:
    s_ff1_i32_b32 s31, s30
    s_cmp_lt_i32 s31, 0
    s_cbranch_scc1 L_h_srvend
    s_bitset0_b32 s30, s31
    v_readlane_b32 s58, v247, s31
    s_cmp_lt_u32 s31, 16
    s_cselect_b32 s32, s6, s8
    s_cselect_b32 s33, s7, s9
    s_cselect_b32 s56, 8, 24
    s_lshr_b32 s57, s2, 4
    s_add_u32 s56, s56, s57
    s_and_b32 s57, s58, 255
    s_cmp_le_u32 s56, s57
    s_cbranch_scc1 L_h_srv
    s_bfe_u32 s58, s58, 0x80008
    s_lshl_b32 s58, s58, 20
    s_lshl_b32 s56, s2, 12
    s_add_u32 s56, s56, s58
    buffer_load_dword v16, v45, s[32:35], s56 offen
    s_branch L_h_srv
L_h_srvend:
    s_mov_b64 exec, -1
    s_bitcmp1_b64 s[86:87], s51
    s_addc_u32 s65, s65, 0
    s_add_u32 s51, s51, 1
    s_cmp_lt_u32 s51, 39
    s_cbranch_scc1 L_h_loop
    s_and_b32 s52, s2, 1
    s_bfe_u32 s58, s2, 0x20001
    s_lshl2_add_u32 s52, s52, s58
    s_mul_i32 s52, s52, 73728
    s_add_u32 s52, s52, 1048576
    v_mul_u32_u24 v244, 1152, v18
    s_mov_b32 s54, 0x3e0293ee
    s_barrier
    s_barrier
    s_sub_u32 s55, s55, 294912
    s_barrier
    ds_read_b128 v[20:23], v17 offset:2048
    ds_read_b128 v[24:27], v17 offset:2064
    s_waitcnt lgkmcnt(0)
    v_add_f32 v20, v20, v21
    v_add_f32 v22, v22, v23
    v_max3_f32 v3, v24, v25, v26
    v_add_f32 v2, v20, v22
    v_max_f32 v3, v3, v27
    v_and_b32 v2, -2, v2
    v_and_b32 v3, -2, v3
    s_mov_b64 exec, 65535
    buffer_store_dwordx2 v[2:3], v240, s[40:43], s55 offen offset:1024 sc1
    s_mov_b64 exec, -1
    s_barrier
    buffer_load_dwordx2 v[246:247], v244, s[40:43], s52 offen offset:1024 sc1
    s_waitcnt vmcnt(0)
L_pollml:
    v_or_b32 v0, v246, v247
    v_and_b32 v0, 1, v0
    v_cmp_eq_u32 vcc, 1, v0
    s_and_b64 exec, exec, vcc
    s_cbranch_scc0 L_mlok
    buffer_load_dwordx2 v[246:247], v244, s[40:43], s52 offen offset:1024 sc1
    s_waitcnt vmcnt(0)
    s_branch L_pollml
L_mlok:
    s_mov_b64 exec, -1
    s_nop 0
    v_max_f32_dpp v46, v247, v247 quad_perm:[1,0,3,2] row_mask:0xf bank_mask:0xf
    v_sub_f32 v46, v247, v46
    v_mul_f32 v46, s54, v46
    v_exp_f32 v46, v46
    s_nop 0
    v_mul_f32 v47, v46, v246
    s_nop 1
    v_add_f32_dpp v47, v47, v47 quad_perm:[1,0,3,2] row_mask:0xf bank_mask:0xf
    v_rcp_f32 v47, v47
    s_nop 0
    v_mul_f32 v46, v46, v47
    ds_write_b32 v240, v46 offset:2816
    s_waitcnt lgkmcnt(0)
    s_barrier
L_end:
    s_endpgm
.section .rodata,"a"
.p2align 6
.amdhsa_kernel concat_heads__gqa_block_cached__sliding_block_cached__decode_kernel
  .amdhsa_next_free_vgpr 252
  .amdhsa_next_free_sgpr 96
  .amdhsa_accum_offset 252
  .amdhsa_group_segment_fixed_size 0
  .amdhsa_kernarg_size 104
  .amdhsa_user_sgpr_count 2
  .amdhsa_user_sgpr_kernarg_segment_ptr 1
  .amdhsa_system_sgpr_workgroup_id_x 1
.end_amdhsa_kernel
```
